```python
import torch

def _softmax(x, axis=-1):
    return torch.softmax(x, dim=axis)
def _gelu(x):
    return torch.nn.functional.gelu(x, approximate="tanh")
def _silu(x):
    return torch.nn.functional.silu(x)
def _sigmoid(x):
    return torch.sigmoid(x)
def _layernorm(x, axis=-1, eps=1e-5):
    m = x.mean(dim=axis, keepdim=True)
    v = x.var(dim=axis, keepdim=True, unbiased=False)
    return (x - m) / torch.sqrt(v + eps)
def _scatter_add(tgt, idx, src, axis=0):
    return tgt.clone().index_add_(axis, idx, src)
def _segment_sum(src, seg, n):
    out = torch.zeros((n,) + src.shape[1:], dtype=src.dtype)
    return out.index_add_(0, seg, src)
def _pad(x, pw):
    flat = tuple(v for pair in reversed(pw) for v in pair)
    return torch.nn.functional.pad(x, flat)

kernel_name = 'interleave_layers__ssm_conv_h3__ssm_conv_h3__prompt'

def setup_inputs():

    _w = (lambda a: (lambda t: t.to(torch.bfloat16) if t.is_floating_point() else t)(torch.as_tensor(a)))
    def _A_setup():
        B, S, D = 1, 2048, 576
        ks = 4
        return {
            "q": _w((lambda *s: torch.randn(*s, dtype=torch.bfloat16) * 0.05)(B, S, D)),
            "k": _w((lambda *s: torch.randn(*s, dtype=torch.bfloat16) * 0.2)(B, S, D)),
            "v": _w((lambda *s: torch.randn(*s, dtype=torch.bfloat16) * 0.2)(B, S, D)),
            "shift_k": _w((lambda *s: torch.randn(*s, dtype=torch.bfloat16) * 0.2)(D, ks) * 0.5),
            "ssm_k": _w((lambda *s: torch.randn(*s, dtype=torch.bfloat16) * 0.4)(D, S) * (1.0 / S ** 0.5)),
            "ssm_D": _w((lambda *s: torch.randn(*s, dtype=torch.bfloat16) * 0.2)(D)),
        }
    _A_in = _A_setup()

    def _B_setup():
        B, S, D = 1, 2048, 576
        ks = 4
        return {
            "q": _w((lambda *s: torch.randn(*s, dtype=torch.bfloat16) * 0.05)(B, S, D)),
            "k": _w((lambda *s: torch.randn(*s, dtype=torch.bfloat16) * 0.2)(B, S, D)),
            "v": _w((lambda *s: torch.randn(*s, dtype=torch.bfloat16) * 0.2)(B, S, D)),
            "shift_k": _w((lambda *s: torch.randn(*s, dtype=torch.bfloat16) * 0.2)(D, ks) * 0.5),
            "ssm_k": _w((lambda *s: torch.randn(*s, dtype=torch.bfloat16) * 0.4)(D, S) * (1.0 / S ** 0.5)),
            "ssm_D": _w((lambda *s: torch.randn(*s, dtype=torch.bfloat16) * 0.2)(D)),
        }
    _B_in = _B_setup()

    return {
        "A_q": _A_in["q"],
        "A_k": _A_in["k"],
        "A_v": _A_in["v"],
        "A_shift_k": _A_in["shift_k"],
        "A_ssm_k": _A_in["ssm_k"],
        "A_ssm_D": _A_in["ssm_D"],
        "B_q": _B_in["q"],
        "B_k": _B_in["k"],
        "B_v": _B_in["v"],
        "B_shift_k": _B_in["shift_k"],
        "B_ssm_k": _B_in["ssm_k"],
        "B_ssm_D": _B_in["ssm_D"],
    }

def reference(A_q, A_k, A_v, A_shift_k, A_ssm_k, A_ssm_D, B_q, B_k, B_v, B_shift_k, B_ssm_k, B_ssm_D):
    def _A_ref(q, k, v, shift_k, ssm_k, ssm_D):
        B, S, D = q.shape
        ks = shift_k.shape[-1]
        k_pad = _pad(k, ((0, 0), (ks - 1, 0), (0, 0)))
        k_shift = torch.zeros_like(k)
        for t in range(ks):
            k_shift = k_shift + k_pad[:, t:t + S, :] * shift_k[:, ks - 1 - t][None, None, :]
        kv = k_shift * v
        L = 2 * S
        kv_pad = _pad(kv, ((0, 0), (0, S), (0, 0)))
        kf_pad = _pad(ssm_k, ((0, 0), (0, S)))
        kv_f = (lambda x, axes=(-2,-1): torch.fft.rfft2(x.float(), dim=axes))(kv_pad[:, None, :, :], axes=(1, 2))
        kf_f = (lambda x, axes=(-2,-1): torch.fft.rfft2(x.float(), dim=axes))(kf_pad[:, None, :], axes=(1, 2))
        kf_f = (lambda x, *d: x.permute(*d))(kf_f, 1, 2, 0)
        y_f = kv_f * kf_f[None, :, :, :]
        y = (lambda x, s, axes=(-2,-1): torch.fft.irfft2(x, s=s, dim=axes).to(torch.bfloat16))(y_f, (1, L), axes=(1, 2))[:, 0, :S, :]
        y = y + kv * ssm_D[None, None, :]
        return q * y

    def _B_ref(q, k, v, shift_k, ssm_k, ssm_D):
        B, S, D = q.shape
        ks = shift_k.shape[-1]
        k_pad = _pad(k, ((0, 0), (ks - 1, 0), (0, 0)))
        k_shift = torch.zeros_like(k)
        for t in range(ks):
            k_shift = k_shift + k_pad[:, t:t + S, :] * shift_k[:, ks - 1 - t][None, None, :]
        kv = k_shift * v
        L = 2 * S
        kv_pad = _pad(kv, ((0, 0), (0, S), (0, 0)))
        kf_pad = _pad(ssm_k, ((0, 0), (0, S)))
        kv_f = (lambda x, axes=(-2,-1): torch.fft.rfft2(x.float(), dim=axes))(kv_pad[:, None, :, :], axes=(1, 2))
        kf_f = (lambda x, axes=(-2,-1): torch.fft.rfft2(x.float(), dim=axes))(kf_pad[:, None, :], axes=(1, 2))
        kf_f = (lambda x, *d: x.permute(*d))(kf_f, 1, 2, 0)
        y_f = kv_f * kf_f[None, :, :, :]
        y = (lambda x, s, axes=(-2,-1): torch.fft.irfft2(x, s=s, dim=axes).to(torch.bfloat16))(y_f, (1, L), axes=(1, 2))[:, 0, :S, :]
        y = y + kv * ssm_D[None, None, :]
        return q * y

    x = A_q
    x = x + _A_ref(_layernorm(x, axis=-1), A_k, A_v, A_shift_k, A_ssm_k, A_ssm_D)
    x = x + _B_ref(_layernorm(x, axis=-1), B_k, B_v, B_shift_k, B_ssm_k, B_ssm_D)
    x = x + _A_ref(_layernorm(x, axis=-1), A_k, A_v, A_shift_k, A_ssm_k, A_ssm_D)
    x = x + _B_ref(_layernorm(x, axis=-1), B_k, B_v, B_shift_k, B_ssm_k, B_ssm_D)
    return x
```

```asm
; @launch grid=(256,1,1) block=(768,1,1) lds=162304
.amdgcn_target "amdgcn-amd-amdhsa--gfx950"
.text
.globl interleave_layers__ssm_conv_h3__ssm_conv_h3__prompt_kernel
.p2align 8
.type interleave_layers__ssm_conv_h3__ssm_conv_h3__prompt_kernel,@function
interleave_layers__ssm_conv_h3__ssm_conv_h3__prompt_kernel:
    s_cmp_ge_u32 s2, 256
    s_cbranch_scc1 L_conv_done
    s_load_dwordx8 s[40:47], s[0:1], 8
    s_load_dwordx2 s[48:49], s[0:1], 40
    s_load_dwordx8 s[52:59], s[0:1], 56
    s_load_dwordx8 s[60:67], s[0:1], 88
    v_lshrrev_b32 v10, 6, v0
    v_and_b32 v0, 63, v0
    v_readfirstlane_b32 s31, v10
    s_mov_b32 s28, 589824
    s_mov_b32 s29, 1179648
    s_mov_b32 s30, 1769472
    s_movk_i32 s5, 1152
    s_and_b32 s3, s2, 7
    s_lshr_b32 s4, s2, 3
    s_lshr_b32 s33, s3, 2
    s_and_b32 s3, s3, 3
    v_lshlrev_b32 v10, 2, v0
    v_add_u32 v10, 162176, v10
    v_mov_b32 v11, 0
    s_mov_b64 exec, 0xffffffff
    ds_write_b32 v10, v11
    s_mov_b64 exec, -1
    s_mul_i32 s6, s3, 18
    s_add_u32 s6, s6, s4
    s_lshl_b32 s32, s6, 3
    s_waitcnt lgkmcnt(0)
    s_barrier
    s_cmp_ge_u32 s4, 18
    s_cbranch_scc1 L_helper
    s_cmp_ge_u32 s31, 8
    s_cbranch_scc1 L_producer
    s_setprio 2
    s_add_u32 s7, s32, s31
    s_cmp_eq_u32 s33, 1
    s_cselect_b64 s[46:47], s[58:59], s[46:47]
    s_cselect_b64 s[48:49], s[60:61], s[48:49]
    s_mov_b32 s16, s46
    s_and_b32 s17, s47, 0xffff
    s_mov_b32 s18, 2359296
    s_mov_b32 s19, 0x20000
    v_lshlrev_b32 v17, 4, v0
    s_lshl_b32 s40, s7, 12
    s_mov_b32 s44, 0
    s_mov_b32 s45, 0x80000000
    buffer_load_dwordx4 v[40:43], v17, s[16:19], s40 offen
    s_mov_b32 exec_hi, 0x1ff
    buffer_load_dwordx4 v[44:47], v17, s[16:19], s40 offen offset:1024
    s_mov_b64 exec, s[44:45]
    buffer_load_dword v48, v17, s[16:19], s40 offen offset:16
    s_mov_b64 exec, -1
    s_add_u32 s40, s40, 1504
    buffer_load_dwordx4 v[60:63], v17, s[16:19], s40 offen offset:0
    buffer_load_dwordx4 v[64:67], v17, s[16:19], s40 offen offset:1024
    s_mov_b32 exec_hi, 7
    buffer_load_dwordx4 v[68:71], v17, s[16:19], s40 offen offset:2048
    s_mov_b64 exec, s[44:45]
    buffer_load_dwordx2 v[36:37], v17, s[16:19], s40 offen offset:16
    buffer_load_dwordx2 v[38:39], v17, s[16:19], s40 offen offset:1040
    s_mov_b64 exec, -1
    s_lshl_b32 s37, s7, 1
    s_and_b32 s37, s37, 0xfffffffc
    s_load_dword s36, s[48:49], s37
    v_mov_b32 v5, 1
    v_mov_b32 v18, 162176
    s_mov_b64 exec, 1
    ds_add_u32 v18, v5 offset:64
    s_mov_b64 exec, -1
    s_mul_i32 s39, s31, 4160
    s_add_u32 s39, s39, 120704
    v_and_b32 v13, 15, v0
    v_lshrrev_b32 v14, 4, v0
    s_add_u32 s37, s39, 32
    v_add_u32 v27, s37, v17
    v_and_b32 v16, 1, v0
    v_lshrrev_b32 v18, 1, v0
    v_mul_u32_u24 v18, 1728, v18
    v_lshl_add_u32 v16, v16, 4, v18
    v_add_u32 v26, s39, v16
    v_mov_b32 v20, 0
    v_mov_b32 v21, 0
    v_mov_b32 v22, 0
    v_mov_b32 v23, 0
    v_cmp_eq_u32 s[50:51], 3, v0
    v_and_b32 v16, 1, v13
    v_xor_b32 v16, 1, v16
    v_mul_u32_u24 v16, 1728, v16
    v_add_u32 v19, 1, v13
    v_lshrrev_b32 v18, 1, v19
    v_lshl_add_u32 v16, v18, 2, v16
    v_lshl_add_u32 v16, v14, 4, v16
    v_add_u32 v8, s39, v16
    v_add_u32 v9, 1024, v8
    s_mul_i32 s38, s31, 10496
    s_add_u32 s38, s38, 36736
    v_and_b32 v16, 3, v19
    v_mul_u32_u24 v16, 2624, v16
    v_and_b32 v18, 28, v19
    v_lshl_add_u32 v16, v18, 1, v16
    v_lshl_add_u32 v16, v14, 4, v16
    v_add_u32 v2, s38, v16
    v_add_u32 v7, s38, v17
    s_mul_i32 s38, s31, 4592
    s_add_u32 s37, s38, 480
    v_lshlrev_b32 v16, 5, v13
    v_sub_u32 v16, s37, v16
    v_lshl_add_u32 v1, v14, 4, v16
    s_add_u32 s37, s38, 4096
    v_add_u32 v25, s37, v17
    s_mov_b64 exec, 0x3fffffff
    ds_write_b128 v25, v[20:23]
    s_mov_b64 exec, -1
    v_lshrrev_b32 v16, 2, v13
    v_add_u32 v16, v16, v14
    v_and_b32 v16, 3, v16
    v_lshl_add_u32 v18, v13, 5, s39
    v_lshl_add_u32 v3, v16, 3, v18
    v_mov_b32 v5, 1
    v_mov_b32 v0, 162176
    v_mov_b32 v28, 0xffff
    s_waitcnt lgkmcnt(0)
    s_and_b32 s37, s31, 1
    s_lshl_b32 s37, s37, 4
    s_lshr_b32 s36, s36, s37
    s_lshl_b32 s36, s36, 16
    s_waitcnt vmcnt(7)
    v_lshlrev_b32 v16, 16, v40
    v_add_f32 v16, s36, v16
    v_cvt_pk_bf16_f32 v16, v16, v16
    s_mov_b64 exec, 1
    v_bfi_b32 v40, v28, v16, v40
    s_mov_b64 exec, -1
    ds_write_b128 v27, v[40:43]
    v_readfirstlane_b32 s37, v40
    s_waitcnt vmcnt(6)
    v_mov_b32_dpp v49, v44 wave_shl:1 row_mask:0xf bank_mask:0xf
    s_waitcnt vmcnt(5)
    v_mov_b32_dpp v48, v40 wave_shl:1 row_mask:0xf bank_mask:0xf
    v_alignbit_b32 v56, v45, v44, 16
    v_alignbit_b32 v57, v46, v45, 16
    v_alignbit_b32 v58, v47, v46, 16
    v_alignbit_b32 v59, v49, v47, 16
    v_alignbit_b32 v52, v41, v40, 16
    v_alignbit_b32 v53, v42, v41, 16
    v_alignbit_b32 v54, v43, v42, 16
    v_alignbit_b32 v55, v48, v43, 16
    ds_write_b128 v27, v[52:55] offset:1728
    s_lshl_b32 s37, s37, 16
    v_mov_b32 v16, s37
    v_cndmask_b32 v23, 0, v16, s[50:51]
    s_mov_b32 exec_hi, 0xff
    ds_write_b128 v27, v[44:47] offset:1024
    ds_write_b128 v27, v[56:59] offset:2752
    s_mov_b64 exec, 0xf
    ds_write_b128 v26, v[20:23]
    s_mov_b64 exec, -1
    ds_read2_b32 v[72:73], v8 offset0:0 offset1:1
    ds_read2_b32 v[74:75], v8 offset0:2 offset1:3
    ds_read2_b32 v[104:105], v8 offset0:128 offset1:129
    ds_read2_b32 v[106:107], v8 offset0:130 offset1:131
    ds_read2_b32 v[136:137], v9 offset0:0 offset1:1
    ds_read2_b32 v[138:139], v9 offset0:2 offset1:3
    ds_read2_b32 v[76:77], v8 offset0:16 offset1:17
    ds_read2_b32 v[78:79], v8 offset0:18 offset1:19
    ds_read2_b32 v[108:109], v8 offset0:144 offset1:145
    ds_read2_b32 v[110:111], v8 offset0:146 offset1:147
    ds_read2_b32 v[140:141], v9 offset0:16 offset1:17
    ds_read2_b32 v[142:143], v9 offset0:18 offset1:19
    ds_read2_b32 v[80:81], v8 offset0:32 offset1:33
    ds_read2_b32 v[82:83], v8 offset0:34 offset1:35
    ds_read2_b32 v[112:113], v8 offset0:160 offset1:161
    ds_read2_b32 v[114:115], v8 offset0:162 offset1:163
    ds_read2_b32 v[144:145], v9 offset0:32 offset1:33
    ds_read2_b32 v[146:147], v9 offset0:34 offset1:35
    ds_read2_b32 v[84:85], v8 offset0:48 offset1:49
    ds_read2_b32 v[86:87], v8 offset0:50 offset1:51
    ds_read2_b32 v[116:117], v8 offset0:176 offset1:177
    ds_read2_b32 v[118:119], v8 offset0:178 offset1:179
    ds_read2_b32 v[148:149], v9 offset0:48 offset1:49
    ds_read2_b32 v[150:151], v9 offset0:50 offset1:51
    ds_read2_b32 v[88:89], v8 offset0:64 offset1:65
    ds_read2_b32 v[90:91], v8 offset0:66 offset1:67
    ds_read2_b32 v[120:121], v8 offset0:192 offset1:193
    ds_read2_b32 v[122:123], v8 offset0:194 offset1:195
    ds_read2_b32 v[152:153], v9 offset0:64 offset1:65
    ds_read2_b32 v[154:155], v9 offset0:66 offset1:67
    ds_read2_b32 v[92:93], v8 offset0:80 offset1:81
    ds_read2_b32 v[94:95], v8 offset0:82 offset1:83
    ds_read2_b32 v[124:125], v8 offset0:208 offset1:209
    ds_read2_b32 v[126:127], v8 offset0:210 offset1:211
    ds_read2_b32 v[156:157], v9 offset0:80 offset1:81
    ds_read2_b32 v[158:159], v9 offset0:82 offset1:83
    ds_read2_b32 v[96:97], v8 offset0:96 offset1:97
    ds_read2_b32 v[98:99], v8 offset0:98 offset1:99
    ds_read2_b32 v[128:129], v8 offset0:224 offset1:225
    ds_read2_b32 v[130:131], v8 offset0:226 offset1:227
    ds_read2_b32 v[160:161], v9 offset0:96 offset1:97
    ds_read2_b32 v[162:163], v9 offset0:98 offset1:99
    ds_read2_b32 v[100:101], v8 offset0:112 offset1:113
    ds_read2_b32 v[102:103], v8 offset0:114 offset1:115
    ds_read2_b32 v[132:133], v8 offset0:240 offset1:241
    ds_read2_b32 v[134:135], v8 offset0:242 offset1:243
    ds_read2_b32 v[164:165], v9 offset0:112 offset1:113
    ds_read2_b32 v[166:167], v9 offset0:114 offset1:115
    s_waitcnt vmcnt(1)
    v_mov_b32_dpp v36, v60 wave_shl:1 row_mask:0xf bank_mask:0xf
    v_mov_b32_dpp v37, v61 wave_shl:1 row_mask:0xf bank_mask:0xf
    ds_write_b128 v7, v[60:63] offset:0
    v_alignbit_b32 v32, v61, v60, 16
    v_alignbit_b32 v33, v62, v61, 16
    v_alignbit_b32 v34, v63, v62, 16
    v_alignbit_b32 v35, v36, v63, 16
    ds_write_b128 v7, v[32:35] offset:2624
    v_mov_b32 v60, v61
    v_mov_b32 v61, v62
    v_mov_b32 v62, v63
    v_mov_b32 v63, v36
    ds_write_b128 v7, v[60:63] offset:5248
    v_alignbit_b32 v32, v61, v60, 16
    v_alignbit_b32 v33, v62, v61, 16
    v_alignbit_b32 v34, v63, v62, 16
    v_alignbit_b32 v35, v37, v63, 16
    ds_write_b128 v7, v[32:35] offset:7872
    s_waitcnt vmcnt(0)
    v_mov_b32_dpp v38, v64 wave_shl:1 row_mask:0xf bank_mask:0xf
    v_mov_b32_dpp v39, v65 wave_shl:1 row_mask:0xf bank_mask:0xf
    ds_write_b128 v7, v[64:67] offset:1024
    v_alignbit_b32 v32, v65, v64, 16
    v_alignbit_b32 v33, v66, v65, 16
    v_alignbit_b32 v34, v67, v66, 16
    v_alignbit_b32 v35, v38, v67, 16
    ds_write_b128 v7, v[32:35] offset:3648
    v_mov_b32 v64, v65
    v_mov_b32 v65, v66
    v_mov_b32 v66, v67
    v_mov_b32 v67, v38
    ds_write_b128 v7, v[64:67] offset:6272
    v_alignbit_b32 v32, v65, v64, 16
    v_alignbit_b32 v33, v66, v65, 16
    v_alignbit_b32 v34, v67, v66, 16
    v_alignbit_b32 v35, v39, v67, 16
    ds_write_b128 v7, v[32:35] offset:8896
    v_mov_b32_dpp v10, v68 wave_shl:1 row_mask:0xf bank_mask:0xf
    v_mov_b32_dpp v11, v69 wave_shl:1 row_mask:0xf bank_mask:0xf
    s_mov_b32 exec_hi, 3
    ds_write_b128 v7, v[68:71] offset:2048
    s_mov_b32 exec_hi, -1
    v_alignbit_b32 v32, v69, v68, 16
    v_alignbit_b32 v33, v70, v69, 16
    v_alignbit_b32 v34, v71, v70, 16
    v_alignbit_b32 v35, v10, v71, 16
    s_mov_b32 exec_hi, 3
    ds_write_b128 v7, v[32:35] offset:4672
    s_mov_b32 exec_hi, -1
    v_mov_b32 v68, v69
    v_mov_b32 v69, v70
    v_mov_b32 v70, v71
    v_mov_b32 v71, v10
    s_mov_b32 exec_hi, 3
    ds_write_b128 v7, v[68:71] offset:7296
    s_mov_b32 exec_hi, -1
    v_alignbit_b32 v32, v69, v68, 16
    v_alignbit_b32 v33, v70, v69, 16
    v_alignbit_b32 v34, v71, v70, 16
    v_alignbit_b32 v35, v11, v71, 16
    s_mov_b32 exec_hi, 3
    ds_write_b128 v7, v[32:35] offset:9920
    s_mov_b32 exec_hi, -1
    s_waitcnt lgkmcnt(0)
L_spin1:
    s_sleep 1
    ds_read_b32 v6, v0 offset:0
    s_waitcnt lgkmcnt(0)
    v_readfirstlane_b32 s68, v6
    s_nop 0
    s_cmp_ge_u32 s68, 2
    s_cbranch_scc0 L_spin1
L_spin2:
    s_sleep 1
    ds_read_b32 v6, v0 offset:4
    s_waitcnt lgkmcnt(0)
    v_readfirstlane_b32 s68, v6
    s_nop 0
    s_cmp_ge_u32 s68, 2
    s_cbranch_scc0 L_spin2
    ds_read_b128 v[12:15], v1 offset:3584
    ds_read_b128 v[16:19], v1 offset:3072
    ds_read_b64 v[20:21], v2 offset:0
    ds_read_b64 v[22:23], v2 offset:8
    ds_read_b64 v[24:25], v2 offset:512
    ds_read_b64 v[26:27], v2 offset:520
    ds_read_b64 v[28:29], v2 offset:1024
    ds_read_b64 v[30:31], v2 offset:1032
    s_waitcnt lgkmcnt(7)
    v_mfma_f32_16x16x32_bf16 v[40:43], v[72:75], v[12:15], 0
    v_mfma_f32_16x16x32_bf16 v[44:47], v[104:107], v[12:15], 0
    v_mfma_f32_16x16x32_bf16 v[48:51], v[136:139], v[12:15], 0
    s_waitcnt lgkmcnt(6)
    v_mfma_f32_16x16x32_bf16 v[44:47], v[72:75], v[16:19], v[44:47]
    ds_read_b64 v[32:33], v2 offset:1536
    ds_read_b64 v[34:35], v2 offset:1544
    ds_read_b64 v[36:37], v2 offset:2048
    ds_read_b64 v[38:39], v2 offset:2056
    ds_read_b128 v[8:11], v1 offset:3648
    v_mfma_f32_16x16x32_bf16 v[48:51], v[104:107], v[16:19], v[48:51]
    v_mfma_f32_16x16x32_bf16 v[52:55], v[136:139], v[16:19], 0
    s_waitcnt lgkmcnt(9)
    v_mfma_f32_16x16x32_bf16 v[56:59], v[20:23], v[16:19], 0
    v_mfma_f32_16x16x32_bf16 v[52:55], v[20:23], v[12:15], v[52:55]
    ds_read_b128 v[20:23], v1 offset:3136
    s_waitcnt lgkmcnt(8)
    v_mfma_f32_16x16x32_bf16 v[60:63], v[24:27], v[16:19], 0
    v_mfma_f32_16x16x32_bf16 v[56:59], v[24:27], v[12:15], v[56:59]
    ds_read_b64 v[24:25], v2 offset:64
    ds_read_b64 v[26:27], v2 offset:72
    s_waitcnt lgkmcnt(8)
    v_mfma_f32_16x16x32_bf16 v[64:67], v[28:31], v[16:19], 0
    v_mfma_f32_16x16x32_bf16 v[60:63], v[28:31], v[12:15], v[60:63]
    ds_read_b64 v[28:29], v2 offset:576
    ds_read_b64 v[30:31], v2 offset:584
    s_waitcnt lgkmcnt(8)
    v_mfma_f32_16x16x32_bf16 v[68:71], v[32:35], v[16:19], 0
    v_mfma_f32_16x16x32_bf16 v[64:67], v[32:35], v[12:15], v[64:67]
    ds_read_b64 v[16:17], v2 offset:1088
    ds_read_b64 v[18:19], v2 offset:1096
    s_waitcnt lgkmcnt(8)
    v_mfma_f32_16x16x32_bf16 v[68:71], v[36:39], v[12:15], v[68:71]
    s_waitcnt lgkmcnt(7)
    v_mfma_f32_16x16x32_bf16 v[40:43], v[76:79], v[8:11], v[40:43]
    ds_read_b64 v[32:33], v2 offset:1600
    ds_read_b64 v[34:35], v2 offset:1608
    v_mfma_f32_16x16x32_bf16 v[44:47], v[108:111], v[8:11], v[44:47]
    v_mfma_f32_16x16x32_bf16 v[48:51], v[140:143], v[8:11], v[48:51]
    ds_read_b64 v[36:37], v2 offset:2112
    ds_read_b64 v[38:39], v2 offset:2120
    s_waitcnt lgkmcnt(10)
    v_mfma_f32_16x16x32_bf16 v[44:47], v[76:79], v[20:23], v[44:47]
    ds_read_b128 v[12:15], v1 offset:3712
    v_mfma_f32_16x16x32_bf16 v[48:51], v[108:111], v[20:23], v[48:51]
    v_mfma_f32_16x16x32_bf16 v[52:55], v[140:143], v[20:23], v[52:55]
    s_waitcnt lgkmcnt(9)
    v_mfma_f32_16x16x32_bf16 v[56:59], v[24:27], v[20:23], v[56:59]
    v_mfma_f32_16x16x32_bf16 v[52:55], v[24:27], v[8:11], v[52:55]
    ds_read_b128 v[24:27], v1 offset:3200
    s_waitcnt lgkmcnt(8)
    v_mfma_f32_16x16x32_bf16 v[60:63], v[28:31], v[20:23], v[60:63]
    v_mfma_f32_16x16x32_bf16 v[56:59], v[28:31], v[8:11], v[56:59]
    ds_read_b64 v[28:29], v2 offset:128
    ds_read_b64 v[30:31], v2 offset:136
    s_waitcnt lgkmcnt(8)
    v_mfma_f32_16x16x32_bf16 v[64:67], v[16:19], v[20:23], v[64:67]
    v_mfma_f32_16x16x32_bf16 v[60:63], v[16:19], v[8:11], v[60:63]
    ds_read_b64 v[16:17], v2 offset:640
    ds_read_b64 v[18:19], v2 offset:648
    s_waitcnt lgkmcnt(8)
    v_mfma_f32_16x16x32_bf16 v[68:71], v[32:35], v[20:23], v[68:71]
    v_mfma_f32_16x16x32_bf16 v[64:67], v[32:35], v[8:11], v[64:67]
    ds_read_b64 v[20:21], v2 offset:1152
    ds_read_b64 v[22:23], v2 offset:1160
    s_waitcnt lgkmcnt(8)
    v_mfma_f32_16x16x32_bf16 v[68:71], v[36:39], v[8:11], v[68:71]
    s_waitcnt lgkmcnt(7)
    v_mfma_f32_16x16x32_bf16 v[40:43], v[80:83], v[12:15], v[40:43]
    ds_read_b64 v[32:33], v2 offset:1664
    ds_read_b64 v[34:35], v2 offset:1672
    v_mfma_f32_16x16x32_bf16 v[44:47], v[112:115], v[12:15], v[44:47]
    v_mfma_f32_16x16x32_bf16 v[48:51], v[144:147], v[12:15], v[48:51]
    ds_read_b64 v[36:37], v2 offset:2176
    ds_read_b64 v[38:39], v2 offset:2184
    s_waitcnt lgkmcnt(10)
    v_mfma_f32_16x16x32_bf16 v[44:47], v[80:83], v[24:27], v[44:47]
    ds_read_b128 v[8:11], v1 offset:3776
    v_mfma_f32_16x16x32_bf16 v[48:51], v[112:115], v[24:27], v[48:51]
    v_mfma_f32_16x16x32_bf16 v[52:55], v[144:147], v[24:27], v[52:55]
    s_waitcnt lgkmcnt(9)
    v_mfma_f32_16x16x32_bf16 v[56:59], v[28:31], v[24:27], v[56:59]
    v_mfma_f32_16x16x32_bf16 v[52:55], v[28:31], v[12:15], v[52:55]
    ds_read_b128 v[28:31], v1 offset:3264
    s_waitcnt lgkmcnt(8)
    v_mfma_f32_16x16x32_bf16 v[60:63], v[16:19], v[24:27], v[60:63]
    v_mfma_f32_16x16x32_bf16 v[56:59], v[16:19], v[12:15], v[56:59]
    ds_read_b64 v[16:17], v2 offset:192
    ds_read_b64 v[18:19], v2 offset:200
    s_waitcnt lgkmcnt(8)
    v_mfma_f32_16x16x32_bf16 v[64:67], v[20:23], v[24:27], v[64:67]
    v_mfma_f32_16x16x32_bf16 v[60:63], v[20:23], v[12:15], v[60:63]
    ds_read_b64 v[20:21], v2 offset:704
    ds_read_b64 v[22:23], v2 offset:712
    s_waitcnt lgkmcnt(8)
    v_mfma_f32_16x16x32_bf16 v[68:71], v[32:35], v[24:27], v[68:71]
    v_mfma_f32_16x16x32_bf16 v[64:67], v[32:35], v[12:15], v[64:67]
    ds_read_b64 v[24:25], v2 offset:1216
    ds_read_b64 v[26:27], v2 offset:1224
    s_waitcnt lgkmcnt(8)
    v_mfma_f32_16x16x32_bf16 v[68:71], v[36:39], v[12:15], v[68:71]
    s_waitcnt lgkmcnt(7)
    v_mfma_f32_16x16x32_bf16 v[40:43], v[84:87], v[8:11], v[40:43]
    ds_read_b64 v[32:33], v2 offset:1728
    ds_read_b64 v[34:35], v2 offset:1736
    v_mfma_f32_16x16x32_bf16 v[44:47], v[116:119], v[8:11], v[44:47]
    v_mfma_f32_16x16x32_bf16 v[48:51], v[148:151], v[8:11], v[48:51]
    ds_read_b64 v[36:37], v2 offset:2240
    ds_read_b64 v[38:39], v2 offset:2248
    s_waitcnt lgkmcnt(10)
    v_mfma_f32_16x16x32_bf16 v[44:47], v[84:87], v[28:31], v[44:47]
    ds_read_b128 v[12:15], v1 offset:3840
    v_mfma_f32_16x16x32_bf16 v[48:51], v[116:119], v[28:31], v[48:51]
    v_mfma_f32_16x16x32_bf16 v[52:55], v[148:151], v[28:31], v[52:55]
    s_waitcnt lgkmcnt(9)
    v_mfma_f32_16x16x32_bf16 v[56:59], v[16:19], v[28:31], v[56:59]
    v_mfma_f32_16x16x32_bf16 v[52:55], v[16:19], v[8:11], v[52:55]
    ds_read_b128 v[16:19], v1 offset:3328
    s_waitcnt lgkmcnt(8)
    v_mfma_f32_16x16x32_bf16 v[60:63], v[20:23], v[28:31], v[60:63]
    v_mfma_f32_16x16x32_bf16 v[56:59], v[20:23], v[8:11], v[56:59]
    ds_read_b64 v[20:21], v2 offset:256
    ds_read_b64 v[22:23], v2 offset:264
    s_waitcnt lgkmcnt(8)
    v_mfma_f32_16x16x32_bf16 v[64:67], v[24:27], v[28:31], v[64:67]
    v_mfma_f32_16x16x32_bf16 v[60:63], v[24:27], v[8:11], v[60:63]
    ds_read_b64 v[24:25], v2 offset:768
    ds_read_b64 v[26:27], v2 offset:776
    s_waitcnt lgkmcnt(8)
    v_mfma_f32_16x16x32_bf16 v[68:71], v[32:35], v[28:31], v[68:71]
    v_mfma_f32_16x16x32_bf16 v[64:67], v[32:35], v[8:11], v[64:67]
    ds_read_b64 v[28:29], v2 offset:1280
    ds_read_b64 v[30:31], v2 offset:1288
    s_waitcnt lgkmcnt(8)
    v_mfma_f32_16x16x32_bf16 v[68:71], v[36:39], v[8:11], v[68:71]
    s_waitcnt lgkmcnt(7)
    v_mfma_f32_16x16x32_bf16 v[40:43], v[88:91], v[12:15], v[40:43]
    ds_read_b64 v[32:33], v2 offset:1792
    ds_read_b64 v[34:35], v2 offset:1800
    v_mfma_f32_16x16x32_bf16 v[44:47], v[120:123], v[12:15], v[44:47]
    v_mfma_f32_16x16x32_bf16 v[48:51], v[152:155], v[12:15], v[48:51]
    ds_read_b64 v[36:37], v2 offset:2304
    ds_read_b64 v[38:39], v2 offset:2312
    s_waitcnt lgkmcnt(10)
    v_mfma_f32_16x16x32_bf16 v[44:47], v[88:91], v[16:19], v[44:47]
    ds_read_b128 v[8:11], v1 offset:3904
    v_mfma_f32_16x16x32_bf16 v[48:51], v[120:123], v[16:19], v[48:51]
    v_mfma_f32_16x16x32_bf16 v[52:55], v[152:155], v[16:19], v[52:55]
    s_waitcnt lgkmcnt(9)
    v_mfma_f32_16x16x32_bf16 v[56:59], v[20:23], v[16:19], v[56:59]
    v_mfma_f32_16x16x32_bf16 v[52:55], v[20:23], v[12:15], v[52:55]
    ds_read_b128 v[20:23], v1 offset:3392
    s_waitcnt lgkmcnt(8)
    v_mfma_f32_16x16x32_bf16 v[60:63], v[24:27], v[16:19], v[60:63]
    v_mfma_f32_16x16x32_bf16 v[56:59], v[24:27], v[12:15], v[56:59]
    ds_read_b64 v[24:25], v2 offset:320
    ds_read_b64 v[26:27], v2 offset:328
    s_waitcnt lgkmcnt(8)
    v_mfma_f32_16x16x32_bf16 v[64:67], v[28:31], v[16:19], v[64:67]
    v_mfma_f32_16x16x32_bf16 v[60:63], v[28:31], v[12:15], v[60:63]
    ds_read_b64 v[28:29], v2 offset:832
    ds_read_b64 v[30:31], v2 offset:840
    s_waitcnt lgkmcnt(8)
    v_mfma_f32_16x16x32_bf16 v[68:71], v[32:35], v[16:19], v[68:71]
    v_mfma_f32_16x16x32_bf16 v[64:67], v[32:35], v[12:15], v[64:67]
    ds_read_b64 v[16:17], v2 offset:1344
    ds_read_b64 v[18:19], v2 offset:1352
    s_waitcnt lgkmcnt(8)
    v_mfma_f32_16x16x32_bf16 v[68:71], v[36:39], v[12:15], v[68:71]
    s_waitcnt lgkmcnt(7)
    v_mfma_f32_16x16x32_bf16 v[40:43], v[92:95], v[8:11], v[40:43]
    ds_read_b64 v[32:33], v2 offset:1856
    ds_read_b64 v[34:35], v2 offset:1864
    v_mfma_f32_16x16x32_bf16 v[44:47], v[124:127], v[8:11], v[44:47]
    v_mfma_f32_16x16x32_bf16 v[48:51], v[156:159], v[8:11], v[48:51]
    ds_read_b64 v[36:37], v2 offset:2368
    ds_read_b64 v[38:39], v2 offset:2376
    s_waitcnt lgkmcnt(10)
    v_mfma_f32_16x16x32_bf16 v[44:47], v[92:95], v[20:23], v[44:47]
    ds_read_b128 v[12:15], v1 offset:3968
    v_mfma_f32_16x16x32_bf16 v[48:51], v[124:127], v[20:23], v[48:51]
    v_mfma_f32_16x16x32_bf16 v[52:55], v[156:159], v[20:23], v[52:55]
    s_waitcnt lgkmcnt(9)
    v_mfma_f32_16x16x32_bf16 v[56:59], v[24:27], v[20:23], v[56:59]
    v_mfma_f32_16x16x32_bf16 v[52:55], v[24:27], v[8:11], v[52:55]
    ds_read_b128 v[24:27], v1 offset:3456
    s_waitcnt lgkmcnt(8)
    v_mfma_f32_16x16x32_bf16 v[60:63], v[28:31], v[20:23], v[60:63]
    v_mfma_f32_16x16x32_bf16 v[56:59], v[28:31], v[8:11], v[56:59]
    ds_read_b64 v[28:29], v2 offset:384
    ds_read_b64 v[30:31], v2 offset:392
    s_waitcnt lgkmcnt(8)
    v_mfma_f32_16x16x32_bf16 v[64:67], v[16:19], v[20:23], v[64:67]
    v_mfma_f32_16x16x32_bf16 v[60:63], v[16:19], v[8:11], v[60:63]
    ds_read_b64 v[16:17], v2 offset:896
    ds_read_b64 v[18:19], v2 offset:904
    s_waitcnt lgkmcnt(8)
    v_mfma_f32_16x16x32_bf16 v[68:71], v[32:35], v[20:23], v[68:71]
    v_mfma_f32_16x16x32_bf16 v[64:67], v[32:35], v[8:11], v[64:67]
    ds_read_b64 v[20:21], v2 offset:1408
    ds_read_b64 v[22:23], v2 offset:1416
    s_waitcnt lgkmcnt(8)
    v_mfma_f32_16x16x32_bf16 v[68:71], v[36:39], v[8:11], v[68:71]
    s_waitcnt lgkmcnt(7)
    v_mfma_f32_16x16x32_bf16 v[40:43], v[96:99], v[12:15], v[40:43]
    ds_read_b64 v[32:33], v2 offset:1920
    ds_read_b64 v[34:35], v2 offset:1928
    v_mfma_f32_16x16x32_bf16 v[44:47], v[128:131], v[12:15], v[44:47]
    v_mfma_f32_16x16x32_bf16 v[48:51], v[160:163], v[12:15], v[48:51]
    ds_read_b64 v[36:37], v2 offset:2432
    ds_read_b64 v[38:39], v2 offset:2440
    s_waitcnt lgkmcnt(10)
    v_mfma_f32_16x16x32_bf16 v[44:47], v[96:99], v[24:27], v[44:47]
    ds_read_b128 v[8:11], v1 offset:4032
    v_mfma_f32_16x16x32_bf16 v[48:51], v[128:131], v[24:27], v[48:51]
    v_mfma_f32_16x16x32_bf16 v[52:55], v[160:163], v[24:27], v[52:55]
    s_waitcnt lgkmcnt(9)
    v_mfma_f32_16x16x32_bf16 v[56:59], v[28:31], v[24:27], v[56:59]
    v_mfma_f32_16x16x32_bf16 v[52:55], v[28:31], v[12:15], v[52:55]
    ds_read_b128 v[28:31], v1 offset:3520
    s_waitcnt lgkmcnt(8)
    v_mfma_f32_16x16x32_bf16 v[60:63], v[16:19], v[24:27], v[60:63]
    v_mfma_f32_16x16x32_bf16 v[56:59], v[16:19], v[12:15], v[56:59]
    ds_read_b64 v[16:17], v2 offset:448
    ds_read_b64 v[18:19], v2 offset:456
    s_waitcnt lgkmcnt(8)
    v_mfma_f32_16x16x32_bf16 v[64:67], v[20:23], v[24:27], v[64:67]
    v_mfma_f32_16x16x32_bf16 v[60:63], v[20:23], v[12:15], v[60:63]
    ds_read_b64 v[20:21], v2 offset:960
    ds_read_b64 v[22:23], v2 offset:968
    s_waitcnt lgkmcnt(8)
    v_mfma_f32_16x16x32_bf16 v[68:71], v[32:35], v[24:27], v[68:71]
    ds_read_b32 v6, v0 offset:8
    v_mfma_f32_16x16x32_bf16 v[64:67], v[32:35], v[12:15], v[64:67]
    ds_read_b64 v[24:25], v2 offset:1472
    ds_read_b64 v[26:27], v2 offset:1480
    s_waitcnt lgkmcnt(9)
    v_mfma_f32_16x16x32_bf16 v[68:71], v[36:39], v[12:15], v[68:71]
    s_waitcnt lgkmcnt(8)
    v_mfma_f32_16x16x32_bf16 v[40:43], v[100:103], v[8:11], v[40:43]
    ds_read_b64 v[32:33], v2 offset:1984
    ds_read_b64 v[34:35], v2 offset:1992
    v_mfma_f32_16x16x32_bf16 v[44:47], v[132:135], v[8:11], v[44:47]
    v_mfma_f32_16x16x32_bf16 v[48:51], v[164:167], v[8:11], v[48:51]
    ds_read_b64 v[36:37], v2 offset:2496
    ds_read_b64 v[38:39], v2 offset:2504
    s_waitcnt lgkmcnt(11)
    v_mfma_f32_16x16x32_bf16 v[44:47], v[100:103], v[28:31], v[44:47]
    s_waitcnt lgkmcnt(6)
    v_readfirstlane_b32 s68, v6
    s_nop 0
    s_cmp_ge_u32 s68, 2
    s_cbranch_scc0 L_chk2_slow
L_chk2_back:
    ds_read_b128 v[12:15], v1 offset:2560
    v_mfma_f32_16x16x32_bf16 v[48:51], v[132:135], v[28:31], v[48:51]
    ds_read_b32 v6, v0 offset:12
    v_mfma_f32_16x16x32_bf16 v[52:55], v[164:167], v[28:31], v[52:55]
    v_mfma_f32_16x16x32_bf16 v[56:59], v[16:19], v[28:31], v[56:59]
    v_mfma_f32_16x16x32_bf16 v[52:55], v[16:19], v[8:11], v[52:55]
    ds_read_b64 v[16:17], v2 offset:0
    ds_read_b64 v[18:19], v2 offset:8
    v_mfma_f32_16x16x32_bf16 v[60:63], v[20:23], v[28:31], v[60:63]
    v_mfma_f32_16x16x32_bf16 v[56:59], v[20:23], v[8:11], v[56:59]
    s_waitcnt lgkmcnt(2)
    v_readfirstlane_b32 s68, v6
    s_nop 0
    s_cmp_ge_u32 s68, 2
    s_cbranch_scc0 L_chk3_slow
L_chk3_back:
    ds_read_b128 v[20:23], v1 offset:2048
    v_cvt_pk_bf16_f32 v40, v40, v41
    v_cvt_pk_bf16_f32 v41, v42, v43
    ds_write_b64 v3, v[40:41] offset:0
    s_mov_b64 exec, 1
    ds_add_u32 v0, v5 offset:32
    s_mov_b64 exec, -1
    v_mfma_f32_16x16x32_bf16 v[64:67], v[24:27], v[28:31], v[64:67]
    v_mfma_f32_16x16x32_bf16 v[60:63], v[24:27], v[8:11], v[60:63]
    ds_read_b128 v[24:27], v1 offset:2624
    v_mfma_f32_16x16x32_bf16 v[68:71], v[32:35], v[28:31], v[68:71]
    v_cvt_pk_bf16_f32 v44, v44, v45
    v_cvt_pk_bf16_f32 v45, v46, v47
    ds_write_b64 v3, v[44:45] offset:512
    s_mov_b64 exec, 1
    ds_add_u32 v0, v5 offset:36
    s_mov_b64 exec, -1
    v_mfma_f32_16x16x32_bf16 v[64:67], v[32:35], v[8:11], v[64:67]
    ds_read_b64 v[40:41], v2 offset:64
    ds_read_b64 v[42:43], v2 offset:72
    v_mfma_f32_16x16x32_bf16 v[68:71], v[36:39], v[8:11], v[68:71]
    ds_read_b128 v[28:31], v1 offset:2112
    v_mfma_f32_16x16x32_bf16 v[48:51], v[72:75], v[12:15], v[48:51]
    v_mfma_f32_16x16x32_bf16 v[52:55], v[104:107], v[12:15], v[52:55]
    v_mfma_f32_16x16x32_bf16 v[56:59], v[136:139], v[12:15], v[56:59]
    ds_read_b128 v[32:35], v1 offset:2688
    s_waitcnt lgkmcnt(10)
    v_mfma_f32_16x16x32_bf16 v[60:63], v[16:19], v[12:15], v[60:63]
    s_waitcnt lgkmcnt(9)
    v_mfma_f32_16x16x32_bf16 v[52:55], v[72:75], v[20:23], v[52:55]
    v_mfma_f32_16x16x32_bf16 v[56:59], v[104:107], v[20:23], v[56:59]
    ds_read_b64 v[36:37], v2 offset:128
    ds_read_b64 v[38:39], v2 offset:136
    v_mfma_f32_16x16x32_bf16 v[60:63], v[136:139], v[20:23], v[60:63]
    ds_read_b128 v[8:11], v1 offset:2176
    s_waitcnt lgkmcnt(9)
    v_mfma_f32_16x16x32_bf16 v[48:51], v[76:79], v[24:27], v[48:51]
    v_mfma_f32_16x16x32_bf16 v[52:55], v[108:111], v[24:27], v[52:55]
    v_mfma_f32_16x16x32_bf16 v[56:59], v[140:143], v[24:27], v[56:59]
    ds_read_b128 v[44:47], v1 offset:2752
    s_waitcnt lgkmcnt(6)
    v_mfma_f32_16x16x32_bf16 v[60:63], v[40:43], v[24:27], v[60:63]
    s_waitcnt lgkmcnt(5)
    v_mfma_f32_16x16x32_bf16 v[52:55], v[76:79], v[28:31], v[52:55]
    v_mfma_f32_16x16x32_bf16 v[56:59], v[108:111], v[28:31], v[56:59]
    ds_read_b64 v[16:17], v2 offset:192
    ds_read_b64 v[18:19], v2 offset:200
    v_mfma_f32_16x16x32_bf16 v[60:63], v[140:143], v[28:31], v[60:63]
    ds_read_b128 v[12:15], v1 offset:2240
    s_waitcnt lgkmcnt(7)
    v_mfma_f32_16x16x32_bf16 v[48:51], v[80:83], v[32:35], v[48:51]
    v_mfma_f32_16x16x32_bf16 v[52:55], v[112:115], v[32:35], v[52:55]
    v_mfma_f32_16x16x32_bf16 v[56:59], v[144:147], v[32:35], v[56:59]
    ds_read_b128 v[20:23], v1 offset:2816
    s_waitcnt lgkmcnt(6)
    v_mfma_f32_16x16x32_bf16 v[60:63], v[36:39], v[32:35], v[60:63]
    s_waitcnt lgkmcnt(5)
    v_mfma_f32_16x16x32_bf16 v[52:55], v[80:83], v[8:11], v[52:55]
    v_mfma_f32_16x16x32_bf16 v[56:59], v[112:115], v[8:11], v[56:59]
    ds_read_b64 v[40:41], v2 offset:256
    ds_read_b64 v[42:43], v2 offset:264
    v_mfma_f32_16x16x32_bf16 v[60:63], v[144:147], v[8:11], v[60:63]
    ds_read_b128 v[24:27], v1 offset:2304
    s_waitcnt lgkmcnt(7)
    v_mfma_f32_16x16x32_bf16 v[48:51], v[84:87], v[44:47], v[48:51]
    v_mfma_f32_16x16x32_bf16 v[52:55], v[116:119], v[44:47], v[52:55]
    v_mfma_f32_16x16x32_bf16 v[56:59], v[148:151], v[44:47], v[56:59]
    ds_read_b128 v[28:31], v1 offset:2880
    s_waitcnt lgkmcnt(6)
    v_mfma_f32_16x16x32_bf16 v[60:63], v[16:19], v[44:47], v[60:63]
    s_waitcnt lgkmcnt(5)
    v_mfma_f32_16x16x32_bf16 v[52:55], v[84:87], v[12:15], v[52:55]
    v_mfma_f32_16x16x32_bf16 v[56:59], v[116:119], v[12:15], v[56:59]
    ds_read_b64 v[36:37], v2 offset:320
    ds_read_b64 v[38:39], v2 offset:328
    v_mfma_f32_16x16x32_bf16 v[60:63], v[148:151], v[12:15], v[60:63]
    ds_read_b128 v[32:35], v1 offset:2368
    s_waitcnt lgkmcnt(7)
    v_mfma_f32_16x16x32_bf16 v[48:51], v[88:91], v[20:23], v[48:51]
    v_mfma_f32_16x16x32_bf16 v[52:55], v[120:123], v[20:23], v[52:55]
    v_mfma_f32_16x16x32_bf16 v[56:59], v[152:155], v[20:23], v[56:59]
    ds_read_b128 v[8:11], v1 offset:2944
    s_waitcnt lgkmcnt(6)
    v_mfma_f32_16x16x32_bf16 v[60:63], v[40:43], v[20:23], v[60:63]
    s_waitcnt lgkmcnt(5)
    v_mfma_f32_16x16x32_bf16 v[52:55], v[88:91], v[24:27], v[52:55]
    v_mfma_f32_16x16x32_bf16 v[56:59], v[120:123], v[24:27], v[56:59]
    ds_read_b64 v[16:17], v2 offset:384
    ds_read_b64 v[18:19], v2 offset:392
    v_mfma_f32_16x16x32_bf16 v[60:63], v[152:155], v[24:27], v[60:63]
    ds_read_b128 v[44:47], v1 offset:2432
    s_waitcnt lgkmcnt(7)
    v_mfma_f32_16x16x32_bf16 v[48:51], v[92:95], v[28:31], v[48:51]
    v_mfma_f32_16x16x32_bf16 v[52:55], v[124:127], v[28:31], v[52:55]
    v_mfma_f32_16x16x32_bf16 v[56:59], v[156:159], v[28:31], v[56:59]
    ds_read_b128 v[12:15], v1 offset:3008
    s_waitcnt lgkmcnt(6)
    v_mfma_f32_16x16x32_bf16 v[60:63], v[36:39], v[28:31], v[60:63]
    ds_read_b32 v6, v0 offset:16
    s_waitcnt lgkmcnt(6)
    v_mfma_f32_16x16x32_bf16 v[52:55], v[92:95], v[32:35], v[52:55]
    v_mfma_f32_16x16x32_bf16 v[56:59], v[124:127], v[32:35], v[56:59]
    ds_read_b64 v[40:41], v2 offset:448
    ds_read_b64 v[42:43], v2 offset:456
    v_mfma_f32_16x16x32_bf16 v[60:63], v[156:159], v[32:35], v[60:63]
    ds_read_b128 v[20:23], v1 offset:2496
    s_waitcnt lgkmcnt(8)
    v_mfma_f32_16x16x32_bf16 v[48:51], v[96:99], v[8:11], v[48:51]
    v_mfma_f32_16x16x32_bf16 v[52:55], v[128:131], v[8:11], v[52:55]
    v_mfma_f32_16x16x32_bf16 v[56:59], v[160:163], v[8:11], v[56:59]
    s_waitcnt lgkmcnt(3)
    v_readfirstlane_b32 s68, v6
    s_nop 0
    s_cmp_ge_u32 s68, 4
    s_cbranch_scc0 L_chk4_slow
L_chk4_back:
    ds_read_b128 v[24:27], v1 offset:1536
    v_mfma_f32_16x16x32_bf16 v[60:63], v[16:19], v[8:11], v[60:63]
    v_mfma_f32_16x16x32_bf16 v[52:55], v[96:99], v[44:47], v[52:55]
    ds_read_b128 v[36:39], v1 offset:1024
    v_mfma_f32_16x16x32_bf16 v[56:59], v[128:131], v[44:47], v[56:59]
    ds_read_b128 v[28:31], v1 offset:1600
    v_mfma_f32_16x16x32_bf16 v[60:63], v[160:163], v[44:47], v[60:63]
    v_mfma_f32_16x16x32_bf16 v[48:51], v[100:103], v[12:15], v[48:51]
    ds_read_b128 v[32:35], v1 offset:1088
    v_mfma_f32_16x16x32_bf16 v[52:55], v[132:135], v[12:15], v[52:55]
    ds_read_b128 v[16:19], v1 offset:1664
    v_mfma_f32_16x16x32_bf16 v[56:59], v[164:167], v[12:15], v[56:59]
    s_waitcnt lgkmcnt(6)
    v_mfma_f32_16x16x32_bf16 v[60:63], v[40:43], v[12:15], v[60:63]
    ds_read_b128 v[8:11], v1 offset:1152
    s_waitcnt lgkmcnt(6)
    v_mfma_f32_16x16x32_bf16 v[52:55], v[100:103], v[20:23], v[52:55]
    ds_read_b128 v[44:47], v1 offset:1728
    v_mfma_f32_16x16x32_bf16 v[56:59], v[132:135], v[20:23], v[56:59]
    v_mfma_f32_16x16x32_bf16 v[60:63], v[164:167], v[20:23], v[60:63]
    ds_read_b128 v[40:43], v1 offset:1216
    s_waitcnt lgkmcnt(7)
    v_mfma_f32_16x16x32_bf16 v[56:59], v[72:75], v[24:27], v[56:59]
    ds_read_b128 v[12:15], v1 offset:1792
    v_mfma_f32_16x16x32_bf16 v[60:63], v[104:107], v[24:27], v[60:63]
    s_waitcnt lgkmcnt(7)
    v_mfma_f32_16x16x32_bf16 v[60:63], v[72:75], v[36:39], v[60:63]
    ds_read_b128 v[20:23], v1 offset:1280
    v_cvt_pk_bf16_f32 v48, v48, v49
    v_cvt_pk_bf16_f32 v49, v50, v51
    ds_write_b64 v3, v[48:49] offset:1024
    s_mov_b64 exec, 1
    ds_add_u32 v0, v5 offset:40
    s_mov_b64 exec, -1
    s_waitcnt lgkmcnt(9)
    v_mfma_f32_16x16x32_bf16 v[56:59], v[76:79], v[28:31], v[56:59]
    ds_read_b128 v[24:27], v1 offset:1856
    v_mfma_f32_16x16x32_bf16 v[60:63], v[108:111], v[28:31], v[60:63]
    s_waitcnt lgkmcnt(9)
    v_mfma_f32_16x16x32_bf16 v[60:63], v[76:79], v[32:35], v[60:63]
    ds_read_b128 v[36:39], v1 offset:1344
    s_waitcnt lgkmcnt(9)
    v_mfma_f32_16x16x32_bf16 v[56:59], v[80:83], v[16:19], v[56:59]
    ds_read_b128 v[28:31], v1 offset:1920
    v_cvt_pk_bf16_f32 v52, v52, v53
    v_cvt_pk_bf16_f32 v53, v54, v55
    ds_write_b64 v3, v[52:53] offset:1536
    s_mov_b64 exec, 1
    ds_add_u32 v0, v5 offset:44
    s_mov_b64 exec, -1
    v_mfma_f32_16x16x32_bf16 v[60:63], v[112:115], v[16:19], v[60:63]
    s_waitcnt lgkmcnt(11)
    v_mfma_f32_16x16x32_bf16 v[60:63], v[80:83], v[8:11], v[60:63]
    ds_read_b128 v[48:51], v1 offset:1408
    s_waitcnt lgkmcnt(11)
    v_mfma_f32_16x16x32_bf16 v[56:59], v[84:87], v[44:47], v[56:59]
    ds_read_b128 v[32:35], v1 offset:1984
    v_mfma_f32_16x16x32_bf16 v[60:63], v[116:119], v[44:47], v[60:63]
    s_waitcnt lgkmcnt(11)
    v_mfma_f32_16x16x32_bf16 v[60:63], v[84:87], v[40:43], v[60:63]
    ds_read_b128 v[16:19], v1 offset:1472
    s_waitcnt lgkmcnt(11)
    v_mfma_f32_16x16x32_bf16 v[56:59], v[88:91], v[12:15], v[56:59]
    ds_read_b64 v[8:9], v2 offset:0
    ds_read_b64 v[10:11], v2 offset:8
    ds_read_b128 v[52:55], v1 offset:2048
    v_mfma_f32_16x16x32_bf16 v[60:63], v[120:123], v[12:15], v[60:63]
    ds_read_b64 v[44:45], v2 offset:512
    ds_read_b64 v[46:47], v2 offset:520
    s_waitcnt lgkmcnt(15)
    v_mfma_f32_16x16x32_bf16 v[60:63], v[88:91], v[20:23], v[60:63]
    ds_read_b128 v[40:43], v1 offset:2560
    s_waitcnt lgkmcnt(13)
    v_mfma_f32_16x16x32_bf16 v[56:59], v[92:95], v[24:27], v[56:59]
    ds_read_b64 v[12:13], v2 offset:1024
    ds_read_b64 v[14:15], v2 offset:1032
    v_mfma_f32_16x16x32_bf16 v[60:63], v[124:127], v[24:27], v[60:63]
    ds_read_b128 v[20:23], v1 offset:1536
    s_waitcnt lgkmcnt(15)
    v_mfma_f32_16x16x32_bf16 v[60:63], v[92:95], v[36:39], v[60:63]
    s_waitcnt lgkmcnt(14)
    v_mfma_f32_16x16x32_bf16 v[56:59], v[96:99], v[28:31], v[56:59]
    ds_read_b128 v[24:27], v1 offset:1024
    v_mfma_f32_16x16x32_bf16 v[60:63], v[128:131], v[28:31], v[60:63]
    s_waitcnt lgkmcnt(12)
    v_mfma_f32_16x16x32_bf16 v[60:63], v[96:99], v[48:51], v[60:63]
    ds_read_b64 v[36:37], v2 offset:64
    ds_read_b64 v[38:39], v2 offset:72
    ds_read_b128 v[28:31], v1 offset:2112
    s_waitcnt lgkmcnt(14)
    v_mfma_f32_16x16x32_bf16 v[56:59], v[100:103], v[32:35], v[56:59]
    ds_read_b64 v[48:49], v2 offset:576
    ds_read_b64 v[50:51], v2 offset:584
    v_mfma_f32_16x16x32_bf16 v[60:63], v[132:135], v[32:35], v[60:63]
    ds_read_b128 v[32:35], v1 offset:2624
    s_waitcnt lgkmcnt(15)
    v_mfma_f32_16x16x32_bf16 v[60:63], v[100:103], v[16:19], v[60:63]
    ds_read_b64 v[16:17], v2 offset:1088
    ds_read_b64 v[18:19], v2 offset:1096
    s_waitcnt lgkmcnt(15)
    v_mfma_f32_16x16x32_bf16 v[64:67], v[8:11], v[52:55], v[64:67]
    s_waitcnt lgkmcnt(13)
    v_mfma_f32_16x16x32_bf16 v[68:71], v[44:47], v[52:55], v[68:71]
    ds_read_b128 v[52:55], v1 offset:1600
    s_waitcnt lgkmcnt(13)
    v_mfma_f32_16x16x32_bf16 v[64:67], v[44:47], v[40:43], v[64:67]
    ds_read_b128 v[44:47], v1 offset:1088
    s_waitcnt lgkmcnt(12)
    v_mfma_f32_16x16x32_bf16 v[68:71], v[12:15], v[40:43], v[68:71]
    s_waitcnt lgkmcnt(11)
    v_mfma_f32_16x16x32_bf16 v[68:71], v[8:11], v[20:23], v[68:71]
    ds_read_b64 v[12:13], v2 offset:128
    ds_read_b64 v[14:15], v2 offset:136
    ds_read_b128 v[40:43], v1 offset:2176
    v_mfma_f32_16x16x32_bf16 v[64:67], v[136:139], v[20:23], v[64:67]
    ds_read_b64 v[8:9], v2 offset:640
    ds_read_b64 v[10:11], v2 offset:648
    s_setprio 1
    s_waitcnt lgkmcnt(15)
    v_mfma_f32_16x16x32_bf16 v[64:67], v[104:107], v[24:27], v[64:67]
    ds_read_b128 v[20:23], v1 offset:2688
    v_cvt_pk_bf16_f32 v56, v56, v57
    v_cvt_pk_bf16_f32 v57, v58, v59
    ds_write_b64 v3, v[56:57] offset:2048
    s_mov_b64 exec, 1
    ds_add_u32 v0, v5 offset:48
    s_mov_b64 exec, -1
    v_mfma_f32_16x16x32_bf16 v[68:71], v[136:139], v[24:27], v[68:71]
    ds_read_b64 v[24:25], v2 offset:1152
    ds_read_b64 v[26:27], v2 offset:1160
    s_waitcnt lgkmcnt(15)
    v_mfma_f32_16x16x32_bf16 v[64:67], v[36:39], v[28:31], v[64:67]
    v_cvt_pk_bf16_f32 v60, v60, v61
    v_cvt_pk_bf16_f32 v61, v62, v63
    ds_write_b64 v3, v[60:61] offset:2560
    s_mov_b64 exec, 1
    ds_add_u32 v0, v5 offset:52
    s_mov_b64 exec, -1
    v_mfma_f32_16x16x32_bf16 v[68:71], v[48:51], v[28:31], v[68:71]
    ds_read_b128 v[56:59], v1 offset:1664
    s_waitcnt lgkmcnt(15)
    v_mfma_f32_16x16x32_bf16 v[64:67], v[48:51], v[32:35], v[64:67]
    ds_read_b128 v[28:31], v1 offset:1152
    v_mfma_f32_16x16x32_bf16 v[68:71], v[16:19], v[32:35], v[68:71]
    s_waitcnt lgkmcnt(15)
    v_mfma_f32_16x16x32_bf16 v[68:71], v[36:39], v[52:55], v[68:71]
    ds_read_b64 v[48:49], v2 offset:192
    ds_read_b64 v[50:51], v2 offset:200
    ds_read_b128 v[60:63], v1 offset:2240
    v_mfma_f32_16x16x32_bf16 v[64:67], v[140:143], v[52:55], v[64:67]
    ds_read_b64 v[16:17], v2 offset:704
    ds_read_b64 v[18:19], v2 offset:712
    s_waitcnt lgkmcnt(15)
    v_mfma_f32_16x16x32_bf16 v[64:67], v[108:111], v[44:47], v[64:67]
    ds_read_b128 v[32:35], v1 offset:2752
    v_mfma_f32_16x16x32_bf16 v[68:71], v[140:143], v[44:47], v[68:71]
    ds_read_b64 v[36:37], v2 offset:1216
    ds_read_b64 v[38:39], v2 offset:1224
    v_mfma_f32_16x16x32_bf16 v[64:67], v[12:15], v[40:43], v[64:67]
    ds_read_b128 v[52:55], v1 offset:1728
    s_waitcnt lgkmcnt(15)
    v_mfma_f32_16x16x32_bf16 v[68:71], v[8:11], v[40:43], v[68:71]
    v_mfma_f32_16x16x32_bf16 v[64:67], v[8:11], v[20:23], v[64:67]
    ds_read_b128 v[44:47], v1 offset:1216
    s_waitcnt lgkmcnt(14)
    v_mfma_f32_16x16x32_bf16 v[68:71], v[24:27], v[20:23], v[68:71]
    s_waitcnt lgkmcnt(11)
    v_mfma_f32_16x16x32_bf16 v[68:71], v[12:15], v[56:59], v[68:71]
    ds_read_b64 v[40:41], v2 offset:256
    ds_read_b64 v[42:43], v2 offset:264
    ds_read_b128 v[8:11], v1 offset:2304
    v_mfma_f32_16x16x32_bf16 v[64:67], v[144:147], v[56:59], v[64:67]
    ds_read_b64 v[24:25], v2 offset:768
    ds_read_b64 v[26:27], v2 offset:776
    s_waitcnt lgkmcnt(15)
    v_mfma_f32_16x16x32_bf16 v[64:67], v[112:115], v[28:31], v[64:67]
    ds_read_b128 v[20:23], v1 offset:2816
    v_mfma_f32_16x16x32_bf16 v[68:71], v[144:147], v[28:31], v[68:71]
    ds_read_b64 v[12:13], v2 offset:1280
    ds_read_b64 v[14:15], v2 offset:1288
    s_waitcnt lgkmcnt(15)
    v_mfma_f32_16x16x32_bf16 v[64:67], v[48:51], v[60:63], v[64:67]
    ds_read_b128 v[56:59], v1 offset:1792
    s_waitcnt lgkmcnt(14)
    v_mfma_f32_16x16x32_bf16 v[68:71], v[16:19], v[60:63], v[68:71]
    s_waitcnt lgkmcnt(13)
    v_mfma_f32_16x16x32_bf16 v[64:67], v[16:19], v[32:35], v[64:67]
    ds_read_b128 v[28:31], v1 offset:1280
    s_waitcnt lgkmcnt(12)
    v_mfma_f32_16x16x32_bf16 v[68:71], v[36:39], v[32:35], v[68:71]
    s_waitcnt lgkmcnt(11)
    v_mfma_f32_16x16x32_bf16 v[68:71], v[48:51], v[52:55], v[68:71]
    ds_read_b64 v[60:61], v2 offset:320
    ds_read_b64 v[62:63], v2 offset:328
    ds_read_b128 v[16:19], v1 offset:2368
    v_mfma_f32_16x16x32_bf16 v[64:67], v[148:151], v[52:55], v[64:67]
    ds_read_b64 v[36:37], v2 offset:832
    ds_read_b64 v[38:39], v2 offset:840
    s_waitcnt lgkmcnt(15)
    v_mfma_f32_16x16x32_bf16 v[64:67], v[116:119], v[44:47], v[64:67]
    ds_read_b128 v[32:35], v1 offset:2880
    v_mfma_f32_16x16x32_bf16 v[68:71], v[148:151], v[44:47], v[68:71]
    ds_read_b64 v[48:49], v2 offset:1344
    ds_read_b64 v[50:51], v2 offset:1352
    s_waitcnt lgkmcnt(15)
    v_mfma_f32_16x16x32_bf16 v[64:67], v[40:43], v[8:11], v[64:67]
    ds_read_b128 v[52:55], v1 offset:1856
    s_waitcnt lgkmcnt(14)
    v_mfma_f32_16x16x32_bf16 v[68:71], v[24:27], v[8:11], v[68:71]
    s_waitcnt lgkmcnt(13)
    v_mfma_f32_16x16x32_bf16 v[64:67], v[24:27], v[20:23], v[64:67]
    ds_read_b128 v[44:47], v1 offset:1344
    s_waitcnt lgkmcnt(12)
    v_mfma_f32_16x16x32_bf16 v[68:71], v[12:15], v[20:23], v[68:71]
    s_waitcnt lgkmcnt(11)
    v_mfma_f32_16x16x32_bf16 v[68:71], v[40:43], v[56:59], v[68:71]
    ds_read_b64 v[8:9], v2 offset:384
    ds_read_b64 v[10:11], v2 offset:392
    ds_read_b128 v[24:27], v1 offset:2432
    v_mfma_f32_16x16x32_bf16 v[64:67], v[152:155], v[56:59], v[64:67]
    ds_read_b64 v[12:13], v2 offset:896
    ds_read_b64 v[14:15], v2 offset:904
    s_waitcnt lgkmcnt(15)
    v_mfma_f32_16x16x32_bf16 v[64:67], v[120:123], v[28:31], v[64:67]
    ds_read_b128 v[20:23], v1 offset:2944
    v_mfma_f32_16x16x32_bf16 v[68:71], v[152:155], v[28:31], v[68:71]
    ds_read_b64 v[40:41], v2 offset:1408
    ds_read_b64 v[42:43], v2 offset:1416
    s_waitcnt lgkmcnt(15)
    v_mfma_f32_16x16x32_bf16 v[64:67], v[60:63], v[16:19], v[64:67]
    ds_read_b128 v[56:59], v1 offset:1920
    s_waitcnt lgkmcnt(14)
    v_mfma_f32_16x16x32_bf16 v[68:71], v[36:39], v[16:19], v[68:71]
    s_waitcnt lgkmcnt(13)
    v_mfma_f32_16x16x32_bf16 v[64:67], v[36:39], v[32:35], v[64:67]
    ds_read_b128 v[28:31], v1 offset:1408
    s_waitcnt lgkmcnt(12)
    v_mfma_f32_16x16x32_bf16 v[68:71], v[48:51], v[32:35], v[68:71]
    s_waitcnt lgkmcnt(11)
    v_mfma_f32_16x16x32_bf16 v[68:71], v[60:63], v[52:55], v[68:71]
    ds_read_b64 v[16:17], v2 offset:448
    ds_read_b64 v[18:19], v2 offset:456
    ds_read_b128 v[36:39], v1 offset:2496
    v_mfma_f32_16x16x32_bf16 v[64:67], v[156:159], v[52:55], v[64:67]
    ds_read_b64 v[48:49], v2 offset:960
    ds_read_b64 v[50:51], v2 offset:968
    s_waitcnt lgkmcnt(15)
    v_mfma_f32_16x16x32_bf16 v[64:67], v[124:127], v[44:47], v[64:67]
    ds_read_b32 v6, v0 offset:20
    ds_read_b128 v[32:35], v1 offset:3008
    v_mfma_f32_16x16x32_bf16 v[68:71], v[156:159], v[44:47], v[68:71]
    ds_read_b64 v[60:61], v2 offset:1472
    ds_read_b64 v[62:63], v2 offset:1480
    s_waitcnt lgkmcnt(15)
    v_mfma_f32_16x16x32_bf16 v[64:67], v[8:11], v[24:27], v[64:67]
    ds_read_b128 v[52:55], v1 offset:1984
    s_waitcnt lgkmcnt(15)
    v_mfma_f32_16x16x32_bf16 v[68:71], v[12:15], v[24:27], v[68:71]
    s_waitcnt lgkmcnt(14)
    v_mfma_f32_16x16x32_bf16 v[64:67], v[12:15], v[20:23], v[64:67]
    ds_read_b128 v[44:47], v1 offset:1472
    s_setprio 0
    s_waitcnt lgkmcnt(13)
    v_mfma_f32_16x16x32_bf16 v[68:71], v[40:43], v[20:23], v[68:71]
    s_waitcnt lgkmcnt(12)
    v_mfma_f32_16x16x32_bf16 v[68:71], v[8:11], v[56:59], v[68:71]
    s_waitcnt lgkmcnt(5)
    v_readfirstlane_b32 s68, v6
    s_nop 0
    s_cmp_ge_u32 s68, 4
    s_cbranch_scc0 L_chk5_slow
L_chk5_back:
    ds_read_b128 v[24:27], v1 offset:512
    v_mfma_f32_16x16x32_bf16 v[64:67], v[160:163], v[56:59], v[64:67]
    ds_read_b128 v[12:15], v1 offset:576
    v_mfma_f32_16x16x32_bf16 v[64:67], v[128:131], v[28:31], v[64:67]
    ds_read_b128 v[40:43], v1 offset:640
    v_mfma_f32_16x16x32_bf16 v[68:71], v[160:163], v[28:31], v[68:71]
    ds_read_b128 v[20:23], v1 offset:704
    v_mfma_f32_16x16x32_bf16 v[64:67], v[16:19], v[36:39], v[64:67]
    ds_read_b128 v[8:11], v1 offset:768
    v_mfma_f32_16x16x32_bf16 v[68:71], v[48:51], v[36:39], v[68:71]
    ds_read_b128 v[56:59], v1 offset:832
    s_waitcnt lgkmcnt(10)
    v_mfma_f32_16x16x32_bf16 v[64:67], v[48:51], v[32:35], v[64:67]
    ds_read_b128 v[28:31], v1 offset:896
    s_waitcnt lgkmcnt(9)
    v_mfma_f32_16x16x32_bf16 v[68:71], v[60:63], v[32:35], v[68:71]
    ds_read_b128 v[36:39], v1 offset:960
    s_waitcnt lgkmcnt(9)
    v_mfma_f32_16x16x32_bf16 v[68:71], v[16:19], v[52:55], v[68:71]
    ds_read_b128 v[48:51], v1 offset:512
    v_mfma_f32_16x16x32_bf16 v[64:67], v[164:167], v[52:55], v[64:67]
    ds_read_b128 v[60:63], v1 offset:0
    s_waitcnt lgkmcnt(10)
    v_mfma_f32_16x16x32_bf16 v[64:67], v[132:135], v[44:47], v[64:67]
    ds_read_b128 v[32:35], v1 offset:576
    v_mfma_f32_16x16x32_bf16 v[68:71], v[164:167], v[44:47], v[68:71]
    ds_read_b128 v[16:19], v1 offset:64
    s_waitcnt lgkmcnt(11)
    v_mfma_f32_16x16x32_bf16 v[64:67], v[72:75], v[24:27], v[64:67]
    ds_read_b128 v[52:55], v1 offset:640
    s_waitcnt lgkmcnt(11)
    v_mfma_f32_16x16x32_bf16 v[64:67], v[76:79], v[12:15], v[64:67]
    ds_read_b128 v[44:47], v1 offset:128
    s_waitcnt lgkmcnt(11)
    v_mfma_f32_16x16x32_bf16 v[64:67], v[80:83], v[40:43], v[64:67]
    ds_read_b128 v[24:27], v1 offset:704
    s_waitcnt lgkmcnt(11)
    v_mfma_f32_16x16x32_bf16 v[64:67], v[84:87], v[20:23], v[64:67]
    ds_read_b128 v[12:15], v1 offset:192
    s_waitcnt lgkmcnt(11)
    v_mfma_f32_16x16x32_bf16 v[64:67], v[88:91], v[8:11], v[64:67]
    ds_read_b128 v[40:43], v1 offset:768
    s_waitcnt lgkmcnt(11)
    v_mfma_f32_16x16x32_bf16 v[64:67], v[92:95], v[56:59], v[64:67]
    ds_read_b128 v[20:23], v1 offset:256
    s_waitcnt lgkmcnt(11)
    v_mfma_f32_16x16x32_bf16 v[64:67], v[96:99], v[28:31], v[64:67]
    ds_read_b128 v[8:11], v1 offset:832
    s_waitcnt lgkmcnt(11)
    v_mfma_f32_16x16x32_bf16 v[64:67], v[100:103], v[36:39], v[64:67]
    ds_read_b128 v[56:59], v1 offset:320
    s_waitcnt lgkmcnt(11)
    v_mfma_f32_16x16x32_bf16 v[68:71], v[104:107], v[48:51], v[68:71]
    ds_read_b128 v[28:31], v1 offset:896
    s_waitcnt lgkmcnt(11)
    v_mfma_f32_16x16x32_bf16 v[68:71], v[72:75], v[60:63], v[68:71]
    ds_read_b128 v[36:39], v1 offset:384
    s_waitcnt lgkmcnt(11)
    v_mfma_f32_16x16x32_bf16 v[68:71], v[108:111], v[32:35], v[68:71]
    ds_read_b128 v[48:51], v1 offset:960
    s_waitcnt lgkmcnt(11)
    v_mfma_f32_16x16x32_bf16 v[68:71], v[76:79], v[16:19], v[68:71]
    ds_read_b128 v[60:63], v1 offset:448
    s_waitcnt lgkmcnt(11)
    v_mfma_f32_16x16x32_bf16 v[68:71], v[112:115], v[52:55], v[68:71]
    s_waitcnt lgkmcnt(10)
    v_mfma_f32_16x16x32_bf16 v[68:71], v[80:83], v[44:47], v[68:71]
    s_waitcnt lgkmcnt(9)
    v_mfma_f32_16x16x32_bf16 v[68:71], v[116:119], v[24:27], v[68:71]
    s_waitcnt lgkmcnt(8)
    v_mfma_f32_16x16x32_bf16 v[68:71], v[84:87], v[12:15], v[68:71]
    s_waitcnt lgkmcnt(7)
    v_mfma_f32_16x16x32_bf16 v[68:71], v[120:123], v[40:43], v[68:71]
    v_cvt_pk_bf16_f32 v64, v64, v65
    v_cvt_pk_bf16_f32 v65, v66, v67
    ds_write_b64 v3, v[64:65] offset:3072
    s_mov_b64 exec, 1
    ds_add_u32 v0, v5 offset:56
    s_mov_b64 exec, -1
    s_waitcnt lgkmcnt(8)
    v_mfma_f32_16x16x32_bf16 v[68:71], v[88:91], v[20:23], v[68:71]
    s_waitcnt lgkmcnt(7)
    v_mfma_f32_16x16x32_bf16 v[68:71], v[124:127], v[8:11], v[68:71]
    s_waitcnt lgkmcnt(6)
    v_mfma_f32_16x16x32_bf16 v[68:71], v[92:95], v[56:59], v[68:71]
    s_waitcnt lgkmcnt(5)
    v_mfma_f32_16x16x32_bf16 v[68:71], v[128:131], v[28:31], v[68:71]
    s_waitcnt lgkmcnt(4)
    v_mfma_f32_16x16x32_bf16 v[68:71], v[96:99], v[36:39], v[68:71]
    s_waitcnt lgkmcnt(3)
    v_mfma_f32_16x16x32_bf16 v[68:71], v[132:135], v[48:51], v[68:71]
    s_waitcnt lgkmcnt(2)
    v_mfma_f32_16x16x32_bf16 v[68:71], v[100:103], v[60:63], v[68:71]
    s_nop 7
    v_cvt_pk_bf16_f32 v68, v68, v69
    v_cvt_pk_bf16_f32 v69, v70, v71
    ds_write_b64 v3, v[68:69] offset:3584
    s_mov_b64 exec, 1
    ds_add_u32 v0, v5 offset:60
    s_mov_b64 exec, -1
    s_endpgm
L_chk2_slow:
    s_sleep 1
    ds_read_b32 v6, v0 offset:8
    s_waitcnt lgkmcnt(0)
    v_readfirstlane_b32 s68, v6
    s_nop 0
    s_cmp_ge_u32 s68, 2
    s_cbranch_scc0 L_chk2_slow
    s_branch L_chk2_back
L_chk3_slow:
    s_sleep 1
    ds_read_b32 v6, v0 offset:12
    s_waitcnt lgkmcnt(0)
    v_readfirstlane_b32 s68, v6
    s_nop 0
    s_cmp_ge_u32 s68, 2
    s_cbranch_scc0 L_chk3_slow
    s_branch L_chk3_back
L_chk4_slow:
    s_sleep 1
    ds_read_b32 v6, v0 offset:16
    s_waitcnt lgkmcnt(0)
    v_readfirstlane_b32 s68, v6
    s_nop 0
    s_cmp_ge_u32 s68, 4
    s_cbranch_scc0 L_chk4_slow
    s_branch L_chk4_back
L_chk5_slow:
    s_sleep 1
    ds_read_b32 v6, v0 offset:20
    s_waitcnt lgkmcnt(0)
    v_readfirstlane_b32 s68, v6
    s_nop 0
    s_cmp_ge_u32 s68, 4
    s_cbranch_scc0 L_chk5_slow
    s_branch L_chk5_back
L_producer:
    s_setprio 3
    s_sub_u32 s4, s31, 8
    s_mov_b32 s34, 0x00030003
    s_mov_b32 s35, 0x00030003
    v_lshrrev_b32 v11, 1, v0
    v_and_b32 v12, 1, v0
    s_lshl_b32 s7, s4, 7
    v_lshl_add_u32 v15, v11, 2, s7
    v_mul_lo_u32 v1, v15, s5
    s_lshl_b32 s37, s32, 1
    v_lshl_add_u32 v16, v12, 3, s37
    v_add_u32 v1, v1, v16
    v_subrev_u32 v2, 3456, v1
    s_lshl_b32 s37, s32, 3
    v_lshl_add_u32 v18, v12, 5, s37
    v_mov_b32 v6, 162176
    v_mov_b32 v7, 1
    s_cmp_eq_u32 s33, 1
    s_cselect_b64 s[40:41], s[52:53], s[40:41]
    s_cselect_b64 s[42:43], s[54:55], s[42:43]
    s_cselect_b64 s[44:45], s[56:57], s[44:45]
    s_cselect_b64 s[46:47], s[58:59], s[46:47]
    s_mov_b32 s8, s40
    s_and_b32 s9, s41, 0xffff
    s_mov_b32 s10, 2359296
    s_mov_b32 s11, 0x20000
    s_mov_b32 s12, s42
    s_and_b32 s13, s43, 0xffff
    s_mov_b32 s14, 2359296
    s_mov_b32 s15, 0x20000
    s_mov_b32 s24, s44
    s_and_b32 s25, s45, 0xffff
    s_mov_b32 s26, 4608
    s_mov_b32 s27, 0x20000
    s_mov_b32 s60, s46
    s_and_b32 s61, s47, 0xffff
    s_mov_b32 s62, 2359296
    s_mov_b32 s63, 0x20000
    buffer_load_dwordx4 v[56:59], v18, s[24:27], 0 offen
    buffer_load_dwordx4 v[60:63], v18, s[24:27], 0 offen offset:16
    s_mov_b32 s6, 0
    s_add_u32 s44, s4, 8
    s_mov_b32 s45, 0
    s_mov_b32 s46, 0
    s_mul_i32 s37, s33, 2359296
    s_add_u32 s50, s66, s37
    s_addc_u32 s51, s67, 0
    s_mov_b32 s20, s50
    s_and_b32 s21, s51, 0xffff
    s_mov_b32 s22, 2359296
    s_mov_b32 s23, 0x20000
    v_mul_u32_u24 v3, 18368, v12
    s_lshl_b32 s37, s7, 1
    s_sub_u32 s37, 4088, s37
    v_lshlrev_b32 v16, 3, v11
    v_sub_u32 v16, s37, v16
    v_add_u32 v3, v3, v16
    v_lshrrev_b32 v13, 2, v0
    v_and_b32 v16, 3, v13
    v_mul_u32_u24 v16, 4160, v16
    s_add_u32 s37, s7, 120704
    v_lshrrev_b32 v14, 4, v0
    v_lshl_add_u32 v19, v14, 5, s37
    v_add_u32 v19, v16, v19
    v_and_b32 v14, 3, v0
    v_add_u32 v16, s4, v14
    v_and_b32 v17, 3, v16
    v_lshl_add_u32 v4, v17, 3, v19
    s_lshl_b32 s37, s4, 4
    v_add_u32 v16, s37, v13
    v_mul_u32_u24 v16, 4608, v16
    s_lshl_b32 s37, s32, 3
    v_lshl_add_u32 v19, v14, 4, s37
    v_add_u32 v5, v16, v19
    s_mov_b32 s16, s64
    s_and_b32 s17, s65, 0xffff
    s_mov_b32 s18, 256
    s_mov_b32 s19, 0x20000
    v_mov_b32 v64, 72
    s_mov_b32 s58, 0
    s_mov_b32 s55, 0
    s_lshr_b32 s37, s4, 1
    s_lshl_b32 s37, s37, 2
    s_add_u32 s47, s37, 162176
    v_mov_b32 v10, 162208
L_ploop:
    s_cmp_ge_u32 s6, 4
    s_cbranch_scc1 L_pnoslot
L_ptok:
    ds_read_b32 v8, v6 offset:64
    s_waitcnt lgkmcnt(0)
    v_readfirstlane_b32 s68, v8
    s_nop 0
    s_cmp_ge_u32 s68, s44
    s_cbranch_scc1 L_pgo
    s_sleep 1
    s_branch L_ptok
L_pgo:
    s_mov_b64 exec, s[34:35]
    buffer_load_dwordx2 v[80:81], v2, s[8:11], 0 offen offset:0
    buffer_load_dwordx2 v[82:83], v2, s[8:11], 0 offen offset:1152
    buffer_load_dwordx2 v[84:85], v2, s[8:11], 0 offen offset:2304
    s_mov_b64 exec, -1
    buffer_load_dwordx2 v[72:73], v1, s[8:11], s45 offen offset:0
    buffer_load_dwordx2 v[86:87], v1, s[12:15], s45 offen offset:0
    buffer_load_dwordx2 v[74:75], v1, s[8:11], s45 offen offset:1152
    buffer_load_dwordx2 v[88:89], v1, s[12:15], s45 offen offset:1152
    buffer_load_dwordx2 v[76:77], v1, s[8:11], s45 offen offset:2304
    buffer_load_dwordx2 v[90:91], v1, s[12:15], s45 offen offset:2304
    buffer_load_dwordx2 v[78:79], v1, s[8:11], s45 offen offset:3456
    s_mov_b64 exec, 1
    ds_add_u32 v6, v7 offset:64
    s_mov_b64 exec, -1
    buffer_load_dwordx2 v[92:93], v1, s[12:15], s45 offen offset:3456
    v_add_u32 v2, 589824, v2
    s_add_u32 s45, s45, 589824
    s_cmp_lg_u32 s44, 999
    s_cbranch_scc1 L_pnc
    buffer_load_dword v66, v64, s[16:19], 0 offen sc1
L_pnc:
    s_add_u32 s44, s44, 4
    v_mov_b32 v9, s47
    s_cmp_lg_u32 s6, 0
    s_cbranch_scc1 L_ptaps
    s_waitcnt vmcnt(11)
    v_lshlrev_b32 v40, 16, v56
    v_and_b32 v44, 0xffff0000, v56
    v_lshlrev_b32 v48, 16, v57
    v_and_b32 v52, 0xffff0000, v57
    v_lshlrev_b32 v41, 16, v58
    v_and_b32 v45, 0xffff0000, v58
    v_lshlrev_b32 v49, 16, v59
    v_and_b32 v53, 0xffff0000, v59
    v_lshlrev_b32 v42, 16, v60
    v_and_b32 v46, 0xffff0000, v60
    v_lshlrev_b32 v50, 16, v61
    v_and_b32 v54, 0xffff0000, v61
    v_lshlrev_b32 v43, 16, v62
    v_and_b32 v47, 0xffff0000, v62
    v_lshlrev_b32 v51, 16, v63
    v_and_b32 v55, 0xffff0000, v63
L_ptaps:
    s_waitcnt vmcnt(5)
    v_mov_b32_dpp v80, v74 row_shr:2 row_mask:0xf bank_mask:0xf
    v_mov_b32_dpp v81, v75 row_shr:2 row_mask:0xf bank_mask:0xf
    s_waitcnt vmcnt(3)
    v_mov_b32_dpp v82, v76 row_shr:2 row_mask:0xf bank_mask:0xf
    v_mov_b32_dpp v83, v77 row_shr:2 row_mask:0xf bank_mask:0xf
    s_waitcnt vmcnt(1)
    v_mov_b32_dpp v84, v78 row_shr:2 row_mask:0xf bank_mask:0xf
    v_mov_b32_dpp v85, v79 row_shr:2 row_mask:0xf bank_mask:0xf
    s_cmp_lg_u32 s6, 0
    s_cbranch_scc1 L_pscal
    v_lshlrev_b32 v96, 16, v80
    v_and_b32 v97, 0xffff0000, v80
    v_lshlrev_b32 v98, 16, v82
    v_and_b32 v99, 0xffff0000, v82
    v_lshlrev_b32 v100, 16, v84
    v_and_b32 v101, 0xffff0000, v84
    v_lshlrev_b32 v102, 16, v72
    v_and_b32 v103, 0xffff0000, v72
    v_lshlrev_b32 v104, 16, v74
    v_and_b32 v105, 0xffff0000, v74
    v_lshlrev_b32 v106, 16, v76
    v_and_b32 v107, 0xffff0000, v76
    v_lshlrev_b32 v108, 16, v78
    v_and_b32 v109, 0xffff0000, v78
    v_pk_mul_f32 v[112:113], v[96:97], v[52:53]
    v_pk_mul_f32 v[114:115], v[98:99], v[52:53]
    v_pk_mul_f32 v[116:117], v[100:101], v[52:53]
    v_pk_mul_f32 v[118:119], v[102:103], v[52:53]
    v_pk_fma_f32 v[112:113], v[98:99], v[48:49], v[112:113]
    v_pk_fma_f32 v[114:115], v[100:101], v[48:49], v[114:115]
    v_pk_fma_f32 v[116:117], v[102:103], v[48:49], v[116:117]
    v_pk_fma_f32 v[118:119], v[104:105], v[48:49], v[118:119]
    v_pk_fma_f32 v[112:113], v[100:101], v[44:45], v[112:113]
    v_pk_fma_f32 v[114:115], v[102:103], v[44:45], v[114:115]
    v_pk_fma_f32 v[116:117], v[104:105], v[44:45], v[116:117]
    v_pk_fma_f32 v[118:119], v[106:107], v[44:45], v[118:119]
    v_pk_fma_f32 v[112:113], v[102:103], v[40:41], v[112:113]
    v_pk_fma_f32 v[114:115], v[104:105], v[40:41], v[114:115]
    v_pk_fma_f32 v[116:117], v[106:107], v[40:41], v[116:117]
    v_pk_fma_f32 v[118:119], v[108:109], v[40:41], v[118:119]
    v_lshlrev_b32 v96, 16, v86
    v_and_b32 v97, 0xffff0000, v86
    v_lshlrev_b32 v98, 16, v88
    v_and_b32 v99, 0xffff0000, v88
    v_lshlrev_b32 v100, 16, v90
    v_and_b32 v101, 0xffff0000, v90
    s_waitcnt vmcnt(0)
    v_lshlrev_b32 v102, 16, v92
    v_and_b32 v103, 0xffff0000, v92
    v_pk_mul_f32 v[112:113], v[112:113], v[96:97]
    v_pk_mul_f32 v[114:115], v[114:115], v[98:99]
    v_pk_mul_f32 v[116:117], v[116:117], v[100:101]
    v_pk_mul_f32 v[118:119], v[118:119], v[102:103]
    v_cvt_pk_bf16_f32 v28, v118, v116
    v_cvt_pk_bf16_f32 v29, v114, v112
    ds_write_b64 v3, v[28:29] offset:0
    v_cvt_pk_bf16_f32 v30, v119, v117
    v_cvt_pk_bf16_f32 v31, v115, v113
    ds_write_b64 v3, v[30:31] offset:4592
    v_lshlrev_b32 v96, 16, v81
    v_and_b32 v97, 0xffff0000, v81
    v_lshlrev_b32 v98, 16, v83
    v_and_b32 v99, 0xffff0000, v83
    v_lshlrev_b32 v100, 16, v85
    v_and_b32 v101, 0xffff0000, v85
    v_lshlrev_b32 v102, 16, v73
    v_and_b32 v103, 0xffff0000, v73
    v_lshlrev_b32 v104, 16, v75
    v_and_b32 v105, 0xffff0000, v75
    v_lshlrev_b32 v106, 16, v77
    v_and_b32 v107, 0xffff0000, v77
    v_lshlrev_b32 v108, 16, v79
    v_and_b32 v109, 0xffff0000, v79
    v_pk_mul_f32 v[112:113], v[96:97], v[54:55]
    v_pk_mul_f32 v[114:115], v[98:99], v[54:55]
    v_pk_mul_f32 v[116:117], v[100:101], v[54:55]
    v_pk_mul_f32 v[118:119], v[102:103], v[54:55]
    v_pk_fma_f32 v[112:113], v[98:99], v[50:51], v[112:113]
    v_pk_fma_f32 v[114:115], v[100:101], v[50:51], v[114:115]
    v_pk_fma_f32 v[116:117], v[102:103], v[50:51], v[116:117]
    v_pk_fma_f32 v[118:119], v[104:105], v[50:51], v[118:119]
    v_pk_fma_f32 v[112:113], v[100:101], v[46:47], v[112:113]
    v_pk_fma_f32 v[114:115], v[102:103], v[46:47], v[114:115]
    v_pk_fma_f32 v[116:117], v[104:105], v[46:47], v[116:117]
    v_pk_fma_f32 v[118:119], v[106:107], v[46:47], v[118:119]
    v_pk_fma_f32 v[112:113], v[102:103], v[42:43], v[112:113]
    v_pk_fma_f32 v[114:115], v[104:105], v[42:43], v[114:115]
    v_pk_fma_f32 v[116:117], v[106:107], v[42:43], v[116:117]
    v_pk_fma_f32 v[118:119], v[108:109], v[42:43], v[118:119]
    v_lshlrev_b32 v96, 16, v87
    v_and_b32 v97, 0xffff0000, v87
    v_lshlrev_b32 v98, 16, v89
    v_and_b32 v99, 0xffff0000, v89
    v_lshlrev_b32 v100, 16, v91
    v_and_b32 v101, 0xffff0000, v91
    v_lshlrev_b32 v102, 16, v93
    v_and_b32 v103, 0xffff0000, v93
    v_pk_mul_f32 v[112:113], v[112:113], v[96:97]
    v_pk_mul_f32 v[114:115], v[114:115], v[98:99]
    v_pk_mul_f32 v[116:117], v[116:117], v[100:101]
    v_pk_mul_f32 v[118:119], v[118:119], v[102:103]
    v_cvt_pk_bf16_f32 v28, v118, v116
    v_cvt_pk_bf16_f32 v29, v114, v112
    ds_write_b64 v3, v[28:29] offset:9184
    v_cvt_pk_bf16_f32 v30, v119, v117
    v_cvt_pk_bf16_f32 v31, v115, v113
    ds_write_b64 v3, v[30:31] offset:13776
    s_branch L_pdone
L_pscal:
    v_lshlrev_b32 v16, 16, v80
    v_lshlrev_b32 v17, 16, v82
    v_lshlrev_b32 v18, 16, v84
    v_lshlrev_b32 v19, 16, v72
    v_lshlrev_b32 v20, 16, v74
    v_lshlrev_b32 v21, 16, v76
    v_lshlrev_b32 v22, 16, v78
    v_mul_f32 v24, v16, v52
    v_mul_f32 v25, v17, v52
    v_mul_f32 v26, v18, v52
    v_mul_f32 v27, v19, v52
    v_fmac_f32 v24, v17, v48
    v_fmac_f32 v25, v18, v48
    v_fmac_f32 v26, v19, v48
    v_fmac_f32 v27, v20, v48
    v_fmac_f32 v24, v18, v44
    v_fmac_f32 v25, v19, v44
    v_fmac_f32 v26, v20, v44
    v_fmac_f32 v27, v21, v44
    v_fmac_f32 v24, v19, v40
    v_fmac_f32 v25, v20, v40
    v_fmac_f32 v26, v21, v40
    v_fmac_f32 v27, v22, v40
    v_lshlrev_b32 v16, 16, v86
    v_lshlrev_b32 v17, 16, v88
    v_lshlrev_b32 v18, 16, v90
    s_waitcnt vmcnt(0)
    v_lshlrev_b32 v19, 16, v92
    v_mul_f32 v24, v24, v16
    v_mul_f32 v25, v25, v17
    v_mul_f32 v26, v26, v18
    v_mul_f32 v27, v27, v19
    v_cvt_pk_bf16_f32 v28, v27, v26
    v_cvt_pk_bf16_f32 v29, v25, v24
    ds_write_b64 v3, v[28:29] offset:0
    v_and_b32 v16, 0xffff0000, v80
    v_and_b32 v17, 0xffff0000, v82
    v_and_b32 v18, 0xffff0000, v84
    v_and_b32 v19, 0xffff0000, v72
    v_and_b32 v20, 0xffff0000, v74
    v_and_b32 v21, 0xffff0000, v76
    v_and_b32 v22, 0xffff0000, v78
    v_mul_f32 v24, v16, v53
    v_mul_f32 v25, v17, v53
    v_mul_f32 v26, v18, v53
    v_mul_f32 v27, v19, v53
    v_fmac_f32 v24, v17, v49
    v_fmac_f32 v25, v18, v49
    v_fmac_f32 v26, v19, v49
    v_fmac_f32 v27, v20, v49
    v_fmac_f32 v24, v18, v45
    v_fmac_f32 v25, v19, v45
    v_fmac_f32 v26, v20, v45
    v_fmac_f32 v27, v21, v45
    v_fmac_f32 v24, v19, v41
    v_fmac_f32 v25, v20, v41
    v_fmac_f32 v26, v21, v41
    v_fmac_f32 v27, v22, v41
    v_and_b32 v16, 0xffff0000, v86
    v_and_b32 v17, 0xffff0000, v88
    v_and_b32 v18, 0xffff0000, v90
    v_and_b32 v19, 0xffff0000, v92
    v_mul_f32 v24, v24, v16
    v_mul_f32 v25, v25, v17
    v_mul_f32 v26, v26, v18
    v_mul_f32 v27, v27, v19
    v_cvt_pk_bf16_f32 v30, v27, v26
    v_cvt_pk_bf16_f32 v31, v25, v24
    ds_write_b64 v3, v[30:31] offset:4592
    v_lshlrev_b32 v16, 16, v81
    v_lshlrev_b32 v17, 16, v83
    v_lshlrev_b32 v18, 16, v85
    v_lshlrev_b32 v19, 16, v73
    v_lshlrev_b32 v20, 16, v75
    v_lshlrev_b32 v21, 16, v77
    v_lshlrev_b32 v22, 16, v79
    v_mul_f32 v24, v16, v54
    v_mul_f32 v25, v17, v54
    v_mul_f32 v26, v18, v54
    v_mul_f32 v27, v19, v54
    v_fmac_f32 v24, v17, v50
    v_fmac_f32 v25, v18, v50
    v_fmac_f32 v26, v19, v50
    v_fmac_f32 v27, v20, v50
    v_fmac_f32 v24, v18, v46
    v_fmac_f32 v25, v19, v46
    v_fmac_f32 v26, v20, v46
    v_fmac_f32 v27, v21, v46
    v_fmac_f32 v24, v19, v42
    v_fmac_f32 v25, v20, v42
    v_fmac_f32 v26, v21, v42
    v_fmac_f32 v27, v22, v42
    v_lshlrev_b32 v16, 16, v87
    v_lshlrev_b32 v17, 16, v89
    v_lshlrev_b32 v18, 16, v91
    v_lshlrev_b32 v19, 16, v93
    v_mul_f32 v24, v24, v16
    v_mul_f32 v25, v25, v17
    v_mul_f32 v26, v26, v18
    v_mul_f32 v27, v27, v19
    v_cvt_pk_bf16_f32 v28, v27, v26
    v_cvt_pk_bf16_f32 v29, v25, v24
    ds_write_b64 v3, v[28:29] offset:9184
    v_and_b32 v16, 0xffff0000, v81
    v_and_b32 v17, 0xffff0000, v83
    v_and_b32 v18, 0xffff0000, v85
    v_and_b32 v19, 0xffff0000, v73
    v_and_b32 v20, 0xffff0000, v75
    v_and_b32 v21, 0xffff0000, v77
    v_and_b32 v22, 0xffff0000, v79
    v_mul_f32 v24, v16, v55
    v_mul_f32 v25, v17, v55
    v_mul_f32 v26, v18, v55
    v_mul_f32 v27, v19, v55
    v_fmac_f32 v24, v17, v51
    v_fmac_f32 v25, v18, v51
    v_fmac_f32 v26, v19, v51
    v_fmac_f32 v27, v20, v51
    v_fmac_f32 v24, v18, v47
    v_fmac_f32 v25, v19, v47
    v_fmac_f32 v26, v20, v47
    v_fmac_f32 v27, v21, v47
    v_fmac_f32 v24, v19, v43
    v_fmac_f32 v25, v20, v43
    v_fmac_f32 v26, v21, v43
    v_fmac_f32 v27, v22, v43
    v_and_b32 v16, 0xffff0000, v87
    v_and_b32 v17, 0xffff0000, v89
    v_and_b32 v18, 0xffff0000, v91
    v_and_b32 v19, 0xffff0000, v93
    v_mul_f32 v24, v24, v16
    v_mul_f32 v25, v25, v17
    v_mul_f32 v26, v26, v18
    v_mul_f32 v27, v27, v19
    v_cvt_pk_bf16_f32 v30, v27, v26
    v_cvt_pk_bf16_f32 v31, v25, v24
    ds_write_b64 v3, v[30:31] offset:13776
L_pdone:
    s_mov_b64 exec, 1
    ds_add_u32 v9, v7 offset:0
    s_mov_b64 exec, -1
    v_subrev_u32 v3, 1024, v3
    s_add_u32 s47, s47, 8
    s_lshl_b32 s37, s6, 2
    s_add_u32 s37, s37, 162188
    s_cmp_ge_u32 s6, 1
    s_cselect_b32 s47, s37, s47
L_pnoslot:
    s_cmp_lt_u32 s6, 3
    s_cbranch_scc1 L_pnoy
    s_mov_b32 s56, 8
    s_mov_b32 s58, 2
    s_mov_b32 s57, 0
    s_cmp_eq_u32 s6, 4
    s_cbranch_scc1 L_ppz2
    s_mov_b32 s56, 3
    s_cmp_lg_u32 s4, 0
    s_cbranch_scc1 L_pyw
    buffer_load_dword v66, v64, s[16:19], 0 offen sc1
    s_branch L_pyw
L_ppz:
    s_waitcnt vmcnt(0)
L_ppz2:
    s_cmp_lg_u32 s4, 0
    s_cbranch_scc1 L_ppz1
    ds_write_b32 v6, v66 offset:68
L_ppz1:
    ds_read_b32 v68, v6 offset:68
    s_waitcnt lgkmcnt(0)
    v_readfirstlane_b32 s68, v68
    s_nop 0
    s_cmp_ge_u32 s68, s58
    s_cbranch_scc1 L_pyw
    s_add_u32 s57, s57, 1
    s_cmp_ge_u32 s57, 2000000
    s_cbranch_scc1 L_pyw
    s_sleep 1
    s_cmp_lg_u32 s4, 0
    s_cbranch_scc1 L_ppz1
    s_sleep 12
    buffer_load_dword v66, v64, s[16:19], 0 offen sc1
    s_branch L_ppz
L_pyw:
    ds_read_b32 v8, v10
    s_waitcnt lgkmcnt(0)
    v_readfirstlane_b32 s68, v8
    s_nop 0
    s_cmp_ge_u32 s68, 8
    s_cbranch_scc1 L_pyg
    s_sleep 1
    s_branch L_pyw
L_pyg:
    ds_read_b64_tr_b16 v[32:33], v4
    ds_read_b64_tr_b16 v[34:35], v4 offset:16640
    v_add_u32 v4, 512, v4
    v_add_u32 v10, 4, v10
    s_add_u32 s55, s55, 1
    s_waitcnt lgkmcnt(1)
    v_min_u32 v36, -2, v32
    v_min_u32 v37, -2, v33
    s_waitcnt lgkmcnt(0)
    v_min_u32 v38, -2, v34
    v_min_u32 v39, -2, v35
    s_waitcnt vmcnt(2)
    buffer_store_dwordx4 v[36:39], v5, s[20:23], s46 offen sc1
    s_add_u32 s46, s46, 294912
    s_cmp_lt_u32 s55, s56
    s_cbranch_scc1 L_pyw
L_pnoy:
    s_add_u32 s6, s6, 1
    s_cmp_lt_u32 s6, 5
    s_cbranch_scc1 L_ploop
    s_endpgm
L_helper:
    s_load_dwordx2 s[38:39], s[0:1], 0
    s_lshl_b32 s36, s4, 4
    s_add_u32 s36, s36, s31
    s_cmp_lg_u32 s36, 497
    s_cbranch_scc1 L_hnc
    s_getpc_b64 s[50:51]
L_pc:
    s_sub_u32 s50, s50, L_pc-interleave_layers__ssm_conv_h3__ssm_conv_h3__prompt_kernel
    s_subb_u32 s51, s51, 0
    s_mov_b32 s8, s50
    s_and_b32 s9, s51, 0xffff
    s_mov_b32 s10, L_conv_done-interleave_layers__ssm_conv_h3__ssm_conv_h3__prompt_kernel
    s_mov_b32 s11, 0x20000
    v_lshlrev_b32 v160, 7, v0
    v_add_u32 v161, 8192, v160
    buffer_load_dword v162, v160, s[8:11], 0 offen
    buffer_load_dword v163, v161, s[8:11], 0 offen
    v_add_u32 v161, 8192, v161
    buffer_load_dword v164, v161, s[8:11], 0 offen
L_hnc:
    s_sub_u32 s4, s4, 18
    s_and_b32 s37, s2, 7
    s_lshl_b32 s6, s4, 3
    s_add_u32 s6, s6, s37
    s_lshr_b32 s44, s31, 2
    s_and_b32 s45, s31, 3
    s_cmp_lt_u32 s45, 3
    s_cbranch_scc1 L_hnopf
    s_mul_i32 s4, s4, 3
    s_add_u32 s4, s4, s44
    s_mul_i32 s4, s4, 13
    v_mul_u32_u24 v2, 86, v0
    v_lshrrev_b32 v2, 8, v2
    v_mul_u32_u24 v3, 3, v2
    v_sub_u32 v3, v0, v3
    v_min_u32 v2, 12, v2
    v_add_u32 v2, s4, v2
    v_min_u32 v2, 511, v2
    v_mul_lo_u32 v2, v2, s5
    s_lshl_b32 s3, s3, 8
    v_lshl_add_u32 v3, v3, 7, s3
    v_add_u32 v2, v2, v3
    s_cmp_eq_u32 s33, 1
    s_cselect_b64 s[40:41], s[52:53], s[40:41]
    s_cselect_b64 s[42:43], s[54:55], s[42:43]
    s_mov_b32 s8, s40
    s_and_b32 s9, s41, 0xffff
    s_mov_b32 s10, 2359296
    s_mov_b32 s11, 0x20000
    s_mov_b32 s12, s42
    s_and_b32 s13, s43, 0xffff
    s_mov_b32 s14, 2359296
    s_mov_b32 s15, 0x20000
    s_mov_b32 exec_hi, 0x7f
    v_mov_b32 v8, 162176
    buffer_load_dword v4, v2, s[8:11], 0 offen offset:0
    buffer_load_dword v6, v2, s[12:15], 0 offen offset:0
    s_waitcnt vmcnt(0)
    v_mov_b32 v9, 1
    ds_max_u32 v8, v9 offset:4
    buffer_load_dword v4, v2, s[8:11], s28 offen offset:0
    buffer_load_dword v6, v2, s[12:15], s28 offen offset:0
    s_waitcnt vmcnt(0)
    v_mov_b32 v9, 2
    ds_max_u32 v8, v9 offset:4
    buffer_load_dword v4, v2, s[8:11], s29 offen offset:0
    buffer_load_dword v6, v2, s[12:15], s29 offen offset:0
    s_waitcnt vmcnt(0)
    v_mov_b32 v9, 3
    ds_max_u32 v8, v9 offset:4
    buffer_load_dword v4, v2, s[8:11], s30 offen offset:0
    buffer_load_dword v6, v2, s[12:15], s30 offen offset:0
    s_waitcnt vmcnt(0)
    v_mov_b32 v9, 4
    ds_max_u32 v8, v9 offset:4
    s_mov_b64 exec, -1
L_hnopf:
    s_waitcnt lgkmcnt(0)
    s_mov_b32 s8, s38
    s_and_b32 s9, s39, 0xffff
    s_mov_b32 s10, 2359296
    s_mov_b32 s11, 0x20000
    s_mov_b32 s12, s62
    s_and_b32 s13, s63, 0xffff
    s_mov_b32 s14, 2359296
    s_mov_b32 s15, 0x20000
    s_mov_b32 s16, s66
    s_and_b32 s17, s67, 0xffff
    s_mov_b32 s18, 4718592
    s_mov_b32 s19, 0x20000
    s_mov_b32 s20, s64
    s_and_b32 s21, s65, 0xffff
    s_mov_b32 s22, 256
    s_mov_b32 s23, 0x20000
    s_mov_b32 s24, 0x3ae38e39
    s_mov_b32 s25, 0x3727c5ac
    s_add_u32 s37, s6, 288
    s_cmp_lt_u32 s6, 96
    s_cselect_b32 s37, s37, -1
    s_add_u32 s40, s6, 496
    s_cmp_lt_u32 s6, 16
    s_cselect_b32 s37, s40, s37
    s_add_u32 s40, s6, 192
    s_cmp_eq_u32 s44, 1
    s_cselect_b32 s37, s40, s37
    s_add_u32 s40, s6, 384
    s_cmp_eq_u32 s44, 0
    s_cselect_b32 s37, s40, s37
    s_mov_b32 s47, s37
    s_max_i32 s37, s37, 192
    s_mul_i32 s7, s37, 4608
    s_sub_u32 s46, s7, 884736
    s_cmp_lt_u32 s47, 384
    s_cselect_b32 s34, 0, 1
    s_cselect_b32 s46, s46, s7
    s_mul_i32 s40, s45, 1152
    v_lshl_add_u32 v1, v0, 4, s40
    v_lshl_add_u32 v2, v0, 1, s40
    s_mul_i32 s41, s44, 18432
    s_lshl_b32 s40, s45, 4
    s_add_u32 s40, s40, s41
    v_lshl_add_u32 v88, v0, 6, s40
    v_lshrrev_b32 v4, 3, v0
    v_and_b32 v5, 7, v0
    v_lshl_add_u32 v4, v4, 6, s40
    v_lshl_add_u32 v89, v5, 1, v4
    s_mul_i32 s40, s45, 3072
    v_lshl_add_u32 v6, v0, 4, s40
    v_add_u32 v87, s41, v6
    v_add_u32 v4, 0, v6
    v_add_u32 v5, 2354688, v4
    v_cmp_gt_u32 vcc, 4608, v4
    s_nop 1
    v_cndmask_b32 v84, v5, v4, vcc
    v_add_u32 v4, 1024, v6
    v_add_u32 v5, 2354688, v4
    v_cmp_gt_u32 vcc, 4608, v4
    s_nop 1
    v_cndmask_b32 v85, v5, v4, vcc
    v_add_u32 v4, 2048, v6
    v_add_u32 v5, 2354688, v4
    v_cmp_gt_u32 vcc, 4608, v4
    s_nop 1
    v_cndmask_b32 v86, v5, v4, vcc
    s_lshl_b32 s40, s44, 3
    s_add_u32 s40, s40, 162184
    v_mov_b32 v90, s40
    v_mov_b32 v98, s24
    v_mov_b32 v99, s25
    v_mov_b32 v4, 162176
    v_mov_b32 v16, 0
    v_mov_b32 v96, 0
    v_mov_b32 v72, -1
    v_mov_b32 v73, -1
    v_mov_b32 v74, -1
    v_mov_b32 v75, -1
    v_mov_b32 v5, 1
    v_mov_b32 v7, 0
    s_cmp_eq_u32 s45, 3
    s_cbranch_scc1 L_cb2
L_spin3:
    s_sleep 1
    ds_read_b32 v6, v4 offset:4
    s_waitcnt lgkmcnt(0)
    v_readfirstlane_b32 s68, v6
    s_nop 0
    s_cmp_ge_u32 s68, 2
    s_cbranch_scc0 L_spin3
    s_cmp_eq_u32 s47, -1
    s_cbranch_scc1 L_cb1
    buffer_store_dwordx4 v[72:75], v84, s[16:19], s7 offen sc1
    buffer_store_dwordx4 v[72:75], v85, s[16:19], s7 offen sc1
    buffer_store_dwordx4 v[72:75], v86, s[16:19], s7 offen sc1
    s_waitcnt vmcnt(0)
L_cb1:
    s_mov_b64 exec, 1
    ds_add_u32 v4, v5 offset:68
    s_mov_b64 exec, -1
L_cb2:
    s_cmp_lg_u32 s31, 0
    s_cbranch_scc1 L_cnp
L_spin4:
    s_sleep 1
    ds_read_b32 v6, v4 offset:68
    s_waitcnt lgkmcnt(0)
    v_readfirstlane_b32 s68, v6
    s_nop 0
    s_cmp_ge_u32 s68, 9
    s_cbranch_scc0 L_spin4
    s_mov_b64 exec, 1
    v_mov_b32 v6, 1
    s_and_b32 s40, s6, 1
    s_lshl_b32 s40, s40, 7
    buffer_atomic_add v6, v7, s[20:23], s40 offen sc0 sc1
    s_waitcnt vmcnt(0)
    v_readfirstlane_b32 s40, v6
    s_nop 0
    s_cmp_lg_u32 s40, 55
    s_cbranch_scc1 L_cny64
    buffer_atomic_add v5, v7, s[20:23], 0 offen offset:72 sc1
L_cny64:
    s_mov_b64 exec, -1
L_cnp:
    buffer_load_dwordx4 v[56:59], v1, s[8:11], s46 offen
    buffer_load_short_d16_hi v16, v2, s[8:11], s46 offen offset:1024
    buffer_load_dwordx4 v[92:95], v1, s[8:11], s7 offen
    buffer_load_short_d16_hi v96, v2, s[8:11], s7 offen offset:1024
    s_mov_b32 s42, 0
    s_cmp_eq_u32 s47, -1
    s_cbranch_scc1 L_conv_done
    s_waitcnt vmcnt(0) lgkmcnt(0)
L_cstage:
    v_mov_b32 v91, 0
    v_lshlrev_b32 v8, 16, v56
    v_and_b32 v9, 0xffff0000, v56
    v_lshlrev_b32 v10, 16, v57
    v_and_b32 v11, 0xffff0000, v57
    v_lshlrev_b32 v12, 16, v58
    v_and_b32 v13, 0xffff0000, v58
    v_lshlrev_b32 v14, 16, v59
    v_and_b32 v15, 0xffff0000, v59
    v_pk_add_f32 v[4:5], v[8:9], v[10:11]
    v_pk_add_f32 v[44:45], v[12:13], v[14:15]
    v_pk_add_f32 v[4:5], v[4:5], v[44:45]
    v_add_f32 v4, v4, v16
    v_add_f32 v4, v4, v5
    s_nop 1
    v_add_f32_dpp v4, v4, v4 quad_perm:[1,0,3,2] row_mask:0xf bank_mask:0xf
    s_nop 1
    v_add_f32_dpp v4, v4, v4 quad_perm:[2,3,0,1] row_mask:0xf bank_mask:0xf
    s_nop 1
    v_add_f32_dpp v4, v4, v4 row_half_mirror row_mask:0xf bank_mask:0xf
    s_nop 1
    v_add_f32_dpp v4, v4, v4 row_mirror row_mask:0xf bank_mask:0xf
    s_nop 1
    v_add_f32_dpp v4, v4, v4 row_bcast:15 row_mask:0xa bank_mask:0xf
    s_nop 1
    v_add_f32_dpp v4, v4, v4 row_bcast:31 row_mask:0xc bank_mask:0xf
    s_nop 0
    v_readlane_b32 s26, v4, 63
    v_mov_b32 v5, s24
    s_nop 0
    v_mul_f32 v4, s26, v5
    v_pk_add_f32 v[8:9], v[8:9], v[4:5] op_sel_hi:[1,0] neg_lo:[0,1] neg_hi:[0,1]
    v_pk_add_f32 v[10:11], v[10:11], v[4:5] op_sel_hi:[1,0] neg_lo:[0,1] neg_hi:[0,1]
    v_pk_add_f32 v[12:13], v[12:13], v[4:5] op_sel_hi:[1,0] neg_lo:[0,1] neg_hi:[0,1]
    v_pk_add_f32 v[14:15], v[14:15], v[4:5] op_sel_hi:[1,0] neg_lo:[0,1] neg_hi:[0,1]
    v_sub_f32 v16, v16, v4
    v_add_f32 v91, v91, v4
    v_pk_add_f32 v[4:5], v[8:9], v[10:11]
    v_pk_mul_f32 v[6:7], v[8:9], v[8:9]
    v_pk_add_f32 v[44:45], v[12:13], v[14:15]
    v_pk_mul_f32 v[46:47], v[10:11], v[10:11]
    v_pk_fma_f32 v[6:7], v[12:13], v[12:13], v[6:7]
    v_pk_add_f32 v[4:5], v[4:5], v[44:45]
    v_pk_fma_f32 v[46:47], v[14:15], v[14:15], v[46:47]
    v_add_f32 v4, v4, v16
    v_pk_add_f32 v[6:7], v[6:7], v[46:47]
    v_add_f32 v4, v4, v5
    v_fmac_f32 v6, v16, v16
    v_add_f32 v6, v6, v7
    v_add_f32_dpp v4, v4, v4 quad_perm:[1,0,3,2] row_mask:0xf bank_mask:0xf
    s_nop 0
    v_add_f32_dpp v6, v6, v6 quad_perm:[1,0,3,2] row_mask:0xf bank_mask:0xf
    v_add_f32_dpp v4, v4, v4 quad_perm:[2,3,0,1] row_mask:0xf bank_mask:0xf
    s_nop 0
    v_add_f32_dpp v6, v6, v6 quad_perm:[2,3,0,1] row_mask:0xf bank_mask:0xf
    v_add_f32_dpp v4, v4, v4 row_half_mirror row_mask:0xf bank_mask:0xf
    s_nop 0
    v_add_f32_dpp v6, v6, v6 row_half_mirror row_mask:0xf bank_mask:0xf
    v_add_f32_dpp v4, v4, v4 row_mirror row_mask:0xf bank_mask:0xf
    s_nop 0
    v_add_f32_dpp v6, v6, v6 row_mirror row_mask:0xf bank_mask:0xf
    v_add_f32_dpp v4, v4, v4 row_bcast:15 row_mask:0xa bank_mask:0xf
    s_nop 0
    v_add_f32_dpp v6, v6, v6 row_bcast:15 row_mask:0xa bank_mask:0xf
    v_add_f32_dpp v4, v4, v4 row_bcast:31 row_mask:0xc bank_mask:0xf
    s_nop 0
    v_add_f32_dpp v6, v6, v6 row_bcast:31 row_mask:0xc bank_mask:0xf
    v_readlane_b32 s26, v4, 63
    v_readlane_b32 s27, v6, 63
    v_mov_b32 v6, s25
    s_nop 0
    v_fmac_f32 v6, s27, v98
    v_rsq_f32 v6, v6
    s_nop 0
    v_mov_b32 v100, v6
    s_cmp_lg_u32 s42, 0
    s_cbranch_scc1 L_cst2
    s_mov_b32 s42, 1
    v_mov_b32 v124, v8
    v_mov_b32 v125, v9
    v_mov_b32 v126, v10
    v_mov_b32 v127, v11
    v_mov_b32 v128, v12
    v_mov_b32 v129, v13
    v_mov_b32 v130, v14
    v_mov_b32 v131, v15
    v_mov_b32 v132, v16
    v_mov_b32 v133, v91
    v_mov_b32 v134, v100
    v_mov_b32 v56, v92
    v_mov_b32 v57, v93
    v_mov_b32 v58, v94
    v_mov_b32 v59, v95
    v_mov_b32 v16, v96
    s_branch L_cstage
L_cst2:
L_cagain:
    v_mov_b32 v28, 0
    v_mov_b32 v40, 0
    s_cmp_eq_u32 s45, 3
    s_cbranch_scc1 L_cbar
    s_sub_u32 s35, s7, 294912
    s_cmp_lt_u32 s7, 4718592
    s_cselect_b32 s35, s7, s35
    s_mov_b32 s43, 0
    s_mov_b32 exec_lo, 0x1
    s_mov_b32 exec_hi, 0x0
L_cprobe:
    buffer_load_dword v72, v85, s[16:19], s35 offen sc1
    s_waitcnt vmcnt(0)
    v_cmp_ne_u32 s[40:41], -1, v72
    s_add_u32 s43, s43, 1
    s_cmp_ge_u32 s43, 2000000
    s_cbranch_scc1 L_cprobed
    s_cmp_lg_u64 s[40:41], 0
    s_cbranch_scc1 L_cprobed
    s_sleep 1
    s_branch L_cprobe
L_cprobed:
    s_mov_b64 exec, -1
    s_mov_b64 s[56:57], -1
    s_mov_b64 s[58:59], -1
    s_mov_b64 s[60:61], -1
L_csweep:
    s_mov_b64 exec, s[56:57]
    s_cbranch_execz L_csk0
    buffer_load_dwordx4 v[72:75], v84, s[16:19], s7 offen sc1
L_csk0:
    s_mov_b64 exec, s[58:59]
    s_cbranch_execz L_csk1
    buffer_load_dwordx4 v[76:79], v85, s[16:19], s7 offen sc1
L_csk1:
    s_mov_b64 exec, s[60:61]
    s_cbranch_execz L_csk2
    buffer_load_dwordx4 v[80:83], v86, s[16:19], s7 offen sc1
L_csk2:
    s_mov_b64 exec, -1
    s_add_u32 s43, s43, 1
    s_waitcnt vmcnt(0)
    v_max3_u32 v4, v72, v73, v74
    v_max3_u32 v5, v76, v77, v78
    v_max3_u32 v6, v80, v81, v82
    v_max_u32 v4, v4, v75
    v_max_u32 v5, v5, v79
    v_max_u32 v6, v6, v83
    v_cmp_eq_u32 s[56:57], -1, v4
    v_cmp_eq_u32 s[58:59], -1, v5
    v_cmp_eq_u32 s[60:61], -1, v6
    s_cmp_ge_u32 s43, 2000000
    s_cbranch_scc1 L_cswept
    s_or_b64 s[40:41], s[56:57], s[58:59]
    s_or_b64 s[40:41], s[40:41], s[60:61]
    s_cbranch_scc1 L_csweep
L_cswept:
    ds_write_b128 v87, v[72:75] offset:0
    ds_write_b128 v87, v[76:79] offset:1024
    ds_write_b128 v87, v[80:83] offset:2048
    v_mov_b32 v5, 1
    s_mov_b64 exec, 1
    ds_add_u32 v90, v5 offset:0
    s_mov_b64 exec, -1
    s_cmp_lg_u32 s34, 0
    s_cbranch_scc1 L_cbar
    buffer_load_dwordx4 v[104:107], v84, s[16:19], s46 offen sc1
    buffer_load_dwordx4 v[108:111], v85, s[16:19], s46 offen sc1
    buffer_load_dwordx4 v[112:115], v86, s[16:19], s46 offen sc1
L_cbar:
    s_waitcnt lgkmcnt(0)
    s_cmp_ge_u32 s47, 384
    s_cbranch_scc1 L_cw
    s_setprio 3
L_cw:
    ds_read_b32 v4, v90
    s_waitcnt lgkmcnt(0)
    v_readfirstlane_b32 s40, v4
    s_nop 0
    s_cmp_ge_u32 s40, 3
    s_cbranch_scc1 L_cgo
    s_cmp_lg_u32 s40, 0
    s_cbranch_scc1 L_cw
    s_sleep 1
    s_branch L_cw
L_cgo:
    ds_read_b128 v[60:63], v88
    ds_read_u16_d16_hi v28, v89 offset:4096
    ds_read_b128 v[64:67], v88 offset:4608
    ds_read_u16_d16_hi v40, v89 offset:8704
    v_mov_b32 v6, v100
    v_mov_b32 v4, 0
    v_pk_fma_f32 v[44:45], v[8:9], v[6:7], v[4:5] op_sel_hi:[1,0,0]
    v_pk_fma_f32 v[46:47], v[10:11], v[6:7], v[4:5] op_sel_hi:[1,0,0]
    v_pk_fma_f32 v[48:49], v[12:13], v[6:7], v[4:5] op_sel_hi:[1,0,0]
    v_pk_fma_f32 v[50:51], v[14:15], v[6:7], v[4:5] op_sel_hi:[1,0,0]
    v_fma_f32 v52, v16, v6, v4
    s_waitcnt lgkmcnt(3)
    v_lshlrev_b32 v20, 16, v60
    v_and_b32 v21, 0xffff0000, v60
    v_lshlrev_b32 v22, 16, v61
    v_and_b32 v23, 0xffff0000, v61
    v_lshlrev_b32 v24, 16, v62
    v_and_b32 v25, 0xffff0000, v62
    v_lshlrev_b32 v26, 16, v63
    v_and_b32 v27, 0xffff0000, v63
    v_pk_fma_f32 v[8:9], v[20:21], v[44:45], v[8:9]
    v_pk_fma_f32 v[10:11], v[22:23], v[46:47], v[10:11]
    v_pk_fma_f32 v[12:13], v[24:25], v[48:49], v[12:13]
    v_pk_fma_f32 v[14:15], v[26:27], v[50:51], v[14:15]
    s_waitcnt lgkmcnt(2)
    v_fmac_f32 v16, v28, v52
    v_pk_add_f32 v[4:5], v[8:9], v[10:11]
    v_pk_mul_f32 v[6:7], v[8:9], v[8:9]
    v_pk_add_f32 v[44:45], v[12:13], v[14:15]
    v_pk_mul_f32 v[46:47], v[10:11], v[10:11]
    v_pk_fma_f32 v[6:7], v[12:13], v[12:13], v[6:7]
    v_pk_add_f32 v[4:5], v[4:5], v[44:45]
    v_pk_fma_f32 v[46:47], v[14:15], v[14:15], v[46:47]
    v_add_f32 v4, v4, v16
    v_pk_add_f32 v[6:7], v[6:7], v[46:47]
    v_add_f32 v4, v4, v5
    v_fmac_f32 v6, v16, v16
    v_add_f32 v6, v6, v7
    v_add_f32_dpp v4, v4, v4 quad_perm:[1,0,3,2] row_mask:0xf bank_mask:0xf
    s_nop 0
    v_add_f32_dpp v6, v6, v6 quad_perm:[1,0,3,2] row_mask:0xf bank_mask:0xf
    v_add_f32_dpp v4, v4, v4 quad_perm:[2,3,0,1] row_mask:0xf bank_mask:0xf
    s_nop 0
    v_add_f32_dpp v6, v6, v6 quad_perm:[2,3,0,1] row_mask:0xf bank_mask:0xf
    v_add_f32_dpp v4, v4, v4 row_half_mirror row_mask:0xf bank_mask:0xf
    s_nop 0
    v_add_f32_dpp v6, v6, v6 row_half_mirror row_mask:0xf bank_mask:0xf
    v_add_f32_dpp v4, v4, v4 row_mirror row_mask:0xf bank_mask:0xf
    s_nop 0
    v_add_f32_dpp v6, v6, v6 row_mirror row_mask:0xf bank_mask:0xf
    v_add_f32_dpp v4, v4, v4 row_bcast:15 row_mask:0xa bank_mask:0xf
    s_nop 0
    v_add_f32_dpp v6, v6, v6 row_bcast:15 row_mask:0xa bank_mask:0xf
    v_add_f32_dpp v4, v4, v4 row_bcast:31 row_mask:0xc bank_mask:0xf
    s_nop 0
    v_add_f32_dpp v6, v6, v6 row_bcast:31 row_mask:0xc bank_mask:0xf
    v_readlane_b32 s26, v4, 63
    v_readlane_b32 s27, v6, 63
    s_waitcnt lgkmcnt(1)
    v_lshlrev_b32 v32, 16, v64
    v_and_b32 v33, 0xffff0000, v64
    v_lshlrev_b32 v34, 16, v65
    v_and_b32 v35, 0xffff0000, v65
    v_lshlrev_b32 v36, 16, v66
    v_and_b32 v37, 0xffff0000, v66
    v_lshlrev_b32 v38, 16, v67
    v_and_b32 v39, 0xffff0000, v67
    v_mul_f32 v4, s26, v98
    v_fma_f32 v6, s27, v98, v99
    v_fma_f32 v6, -v4, v4, v6
    v_max_f32 v6, s25, v6
    v_rsq_f32 v6, v6
    s_nop 0
    v_mul_f32 v4, -v4, v6
    v_pk_fma_f32 v[44:45], v[8:9], v[6:7], v[4:5] op_sel_hi:[1,0,0]
    v_pk_fma_f32 v[46:47], v[10:11], v[6:7], v[4:5] op_sel_hi:[1,0,0]
    v_pk_fma_f32 v[48:49], v[12:13], v[6:7], v[4:5] op_sel_hi:[1,0,0]
    v_pk_fma_f32 v[50:51], v[14:15], v[6:7], v[4:5] op_sel_hi:[1,0,0]
    v_fma_f32 v52, v16, v6, v4
    v_pk_fma_f32 v[8:9], v[32:33], v[44:45], v[8:9]
    v_pk_fma_f32 v[10:11], v[34:35], v[46:47], v[10:11]
    v_pk_fma_f32 v[12:13], v[36:37], v[48:49], v[12:13]
    v_pk_fma_f32 v[14:15], v[38:39], v[50:51], v[14:15]
    s_waitcnt lgkmcnt(0)
    v_fmac_f32 v16, v40, v52
    v_pk_add_f32 v[4:5], v[8:9], v[10:11]
    v_pk_mul_f32 v[6:7], v[8:9], v[8:9]
    v_pk_add_f32 v[44:45], v[12:13], v[14:15]
    v_pk_mul_f32 v[46:47], v[10:11], v[10:11]
    v_pk_fma_f32 v[6:7], v[12:13], v[12:13], v[6:7]
    v_pk_add_f32 v[4:5], v[4:5], v[44:45]
    v_pk_fma_f32 v[46:47], v[14:15], v[14:15], v[46:47]
    v_add_f32 v4, v4, v16
    v_pk_add_f32 v[6:7], v[6:7], v[46:47]
    v_add_f32 v4, v4, v5
    v_fmac_f32 v6, v16, v16
    v_add_f32 v6, v6, v7
    v_add_f32_dpp v4, v4, v4 quad_perm:[1,0,3,2] row_mask:0xf bank_mask:0xf
    s_nop 0
    v_add_f32_dpp v6, v6, v6 quad_perm:[1,0,3,2] row_mask:0xf bank_mask:0xf
    v_add_f32_dpp v4, v4, v4 quad_perm:[2,3,0,1] row_mask:0xf bank_mask:0xf
    s_nop 0
    v_add_f32_dpp v6, v6, v6 quad_perm:[2,3,0,1] row_mask:0xf bank_mask:0xf
    v_add_f32_dpp v4, v4, v4 row_half_mirror row_mask:0xf bank_mask:0xf
    s_nop 0
    v_add_f32_dpp v6, v6, v6 row_half_mirror row_mask:0xf bank_mask:0xf
    v_add_f32_dpp v4, v4, v4 row_mirror row_mask:0xf bank_mask:0xf
    s_nop 0
    v_add_f32_dpp v6, v6, v6 row_mirror row_mask:0xf bank_mask:0xf
    v_add_f32_dpp v4, v4, v4 row_bcast:15 row_mask:0xa bank_mask:0xf
    s_nop 0
    v_add_f32_dpp v6, v6, v6 row_bcast:15 row_mask:0xa bank_mask:0xf
    v_add_f32_dpp v4, v4, v4 row_bcast:31 row_mask:0xc bank_mask:0xf
    s_nop 0
    v_add_f32_dpp v6, v6, v6 row_bcast:31 row_mask:0xc bank_mask:0xf
    v_readlane_b32 s26, v4, 63
    v_readlane_b32 s27, v6, 63
    s_nop 0
    v_mul_f32 v4, s26, v98
    v_fma_f32 v6, s27, v98, v99
    v_fma_f32 v6, -v4, v4, v6
    v_max_f32 v6, s25, v6
    v_rsq_f32 v6, v6
    s_nop 0
    v_mul_f32 v4, -v4, v6
    v_pk_fma_f32 v[44:45], v[8:9], v[6:7], v[4:5] op_sel_hi:[1,0,0]
    v_pk_fma_f32 v[46:47], v[10:11], v[6:7], v[4:5] op_sel_hi:[1,0,0]
    v_pk_fma_f32 v[48:49], v[12:13], v[6:7], v[4:5] op_sel_hi:[1,0,0]
    v_pk_fma_f32 v[50:51], v[14:15], v[6:7], v[4:5] op_sel_hi:[1,0,0]
    v_fma_f32 v52, v16, v6, v4
    v_pk_fma_f32 v[8:9], v[20:21], v[44:45], v[8:9]
    v_pk_fma_f32 v[10:11], v[22:23], v[46:47], v[10:11]
    v_pk_fma_f32 v[12:13], v[24:25], v[48:49], v[12:13]
    v_pk_fma_f32 v[14:15], v[26:27], v[50:51], v[14:15]
    v_fmac_f32 v16, v28, v52
    v_pk_add_f32 v[4:5], v[8:9], v[10:11]
    v_pk_mul_f32 v[6:7], v[8:9], v[8:9]
    v_pk_add_f32 v[44:45], v[12:13], v[14:15]
    v_pk_mul_f32 v[46:47], v[10:11], v[10:11]
    v_pk_fma_f32 v[6:7], v[12:13], v[12:13], v[6:7]
    v_pk_add_f32 v[4:5], v[4:5], v[44:45]
    v_pk_fma_f32 v[46:47], v[14:15], v[14:15], v[46:47]
    v_add_f32 v4, v4, v16
    v_pk_add_f32 v[6:7], v[6:7], v[46:47]
    v_add_f32 v4, v4, v5
    v_fmac_f32 v6, v16, v16
    v_add_f32 v6, v6, v7
    v_add_f32_dpp v4, v4, v4 quad_perm:[1,0,3,2] row_mask:0xf bank_mask:0xf
    s_nop 0
    v_add_f32_dpp v6, v6, v6 quad_perm:[1,0,3,2] row_mask:0xf bank_mask:0xf
    v_add_f32_dpp v4, v4, v4 quad_perm:[2,3,0,1] row_mask:0xf bank_mask:0xf
    s_nop 0
    v_add_f32_dpp v6, v6, v6 quad_perm:[2,3,0,1] row_mask:0xf bank_mask:0xf
    v_add_f32_dpp v4, v4, v4 row_half_mirror row_mask:0xf bank_mask:0xf
    s_nop 0
    v_add_f32_dpp v6, v6, v6 row_half_mirror row_mask:0xf bank_mask:0xf
    v_add_f32_dpp v4, v4, v4 row_mirror row_mask:0xf bank_mask:0xf
    s_nop 0
    v_add_f32_dpp v6, v6, v6 row_mirror row_mask:0xf bank_mask:0xf
    v_add_f32_dpp v4, v4, v4 row_bcast:15 row_mask:0xa bank_mask:0xf
    s_nop 0
    v_add_f32_dpp v6, v6, v6 row_bcast:15 row_mask:0xa bank_mask:0xf
    v_add_f32_dpp v4, v4, v4 row_bcast:31 row_mask:0xc bank_mask:0xf
    s_nop 0
    v_add_f32_dpp v6, v6, v6 row_bcast:31 row_mask:0xc bank_mask:0xf
    v_readlane_b32 s26, v4, 63
    v_readlane_b32 s27, v6, 63
    s_nop 0
    v_mul_f32 v4, s26, v98
    v_fma_f32 v6, s27, v98, v99
    v_fma_f32 v6, -v4, v4, v6
    v_max_f32 v6, s25, v6
    v_rsq_f32 v6, v6
    s_nop 0
    v_mul_f32 v4, -v4, v6
    v_pk_fma_f32 v[44:45], v[8:9], v[6:7], v[4:5] op_sel_hi:[1,0,0]
    v_pk_fma_f32 v[46:47], v[10:11], v[6:7], v[4:5] op_sel_hi:[1,0,0]
    v_pk_fma_f32 v[48:49], v[12:13], v[6:7], v[4:5] op_sel_hi:[1,0,0]
    v_pk_fma_f32 v[50:51], v[14:15], v[6:7], v[4:5] op_sel_hi:[1,0,0]
    v_fma_f32 v52, v16, v6, v4
    v_pk_fma_f32 v[8:9], v[32:33], v[44:45], v[8:9]
    v_pk_fma_f32 v[10:11], v[34:35], v[46:47], v[10:11]
    v_pk_fma_f32 v[12:13], v[36:37], v[48:49], v[12:13]
    v_pk_fma_f32 v[14:15], v[38:39], v[50:51], v[14:15]
    v_fmac_f32 v16, v40, v52
    v_mov_b32 v4, v91
    v_pk_add_f32 v[8:9], v[8:9], v[4:5] op_sel_hi:[1,0]
    v_pk_add_f32 v[10:11], v[10:11], v[4:5] op_sel_hi:[1,0]
    v_pk_add_f32 v[12:13], v[12:13], v[4:5] op_sel_hi:[1,0]
    v_pk_add_f32 v[14:15], v[14:15], v[4:5] op_sel_hi:[1,0]
    v_add_f32 v16, v16, v4
    v_cvt_pk_bf16_f32 v56, v8, v9
    v_cvt_pk_bf16_f32 v57, v10, v11
    v_cvt_pk_bf16_f32 v58, v12, v13
    v_cvt_pk_bf16_f32 v59, v14, v15
    v_cvt_pk_bf16_f32 v60, v16, v16
    buffer_store_dwordx4 v[56:59], v1, s[12:15], s7 offen sc1
    buffer_store_short v60, v2, s[12:15], s7 offen offset:1024 sc1
    s_cmp_lg_u32 s34, 0
    s_cbranch_scc1 L_cend
    s_mov_b32 s34, 2
    s_mov_b32 s7, s46
    v_add_u32 v88, 9216, v88
    v_add_u32 v89, 9216, v89
    v_add_u32 v90, 4, v90
    s_cmp_eq_u32 s45, 3
    s_cbranch_scc1 L_cn2
    s_waitcnt vmcnt(2)
    ds_write_b128 v87, v[104:107] offset:9216
    ds_write_b128 v87, v[108:111] offset:10240
    ds_write_b128 v87, v[112:115] offset:11264
    v_mov_b32 v5, 1
    s_mov_b64 exec, 1
    ds_add_u32 v90, v5 offset:0
    s_mov_b64 exec, -1
L_cn2:
    v_mov_b32 v8, v124
    v_mov_b32 v9, v125
    v_mov_b32 v10, v126
    v_mov_b32 v11, v127
    v_mov_b32 v12, v128
    v_mov_b32 v13, v129
    v_mov_b32 v14, v130
    v_mov_b32 v15, v131
    v_mov_b32 v16, v132
    v_mov_b32 v91, v133
    v_mov_b32 v100, v134
    v_mov_b32 v28, 0
    v_mov_b32 v40, 0
    s_branch L_cbar
L_cend:
L_conv_done:
    s_endpgm
.section .rodata,"a"
.p2align 6
.amdhsa_kernel interleave_layers__ssm_conv_h3__ssm_conv_h3__prompt_kernel
  .amdhsa_next_free_vgpr 168
  .amdhsa_next_free_sgpr 70
  .amdhsa_accum_offset 168
  .amdhsa_group_segment_fixed_size 0
  .amdhsa_kernarg_size 120
  .amdhsa_user_sgpr_count 2
  .amdhsa_user_sgpr_kernarg_segment_ptr 1
  .amdhsa_system_sgpr_workgroup_id_x 1
.end_amdhsa_kernel
```
